```python
import torch

def _softmax(x, axis=-1):
    return torch.softmax(x, dim=axis)
def _gelu(x):
    return torch.nn.functional.gelu(x, approximate="tanh")
def _silu(x):
    return torch.nn.functional.silu(x)
def _sigmoid(x):
    return torch.sigmoid(x)
def _layernorm(x, axis=-1, eps=1e-5):
    m = x.mean(dim=axis, keepdim=True)
    v = x.var(dim=axis, keepdim=True, unbiased=False)
    return (x - m) / torch.sqrt(v + eps)
def _scatter_add(tgt, idx, src, axis=0):
    return tgt.clone().index_add_(axis, idx, src)
def _segment_sum(src, seg, n):
    out = torch.zeros((n,) + src.shape[1:], dtype=src.dtype)
    return out.index_add_(0, seg, src)
def _pad(x, pw):
    flat = tuple(v for pair in reversed(pw) for v in pair)
    return torch.nn.functional.pad(x, flat)

kernel_name = 'parallel_sum__gqa_block_cached__dense_activation_relu__decode'

def setup_inputs():

    _w = (lambda a: (lambda t: t.to(torch.bfloat16) if t.is_floating_point() else t)(torch.as_tensor(a)))
    def _A_setup():
        B, Sq, D = 1, 1, 448
        Hq, Hkv, Sk, Dh = 16, 8, 32768, 256
        assert Hq % Hkv == 0, (Hq, Hkv)
        return {
            "x": _w((lambda *s: torch.randn(*s, dtype=torch.bfloat16) * 0.05)(B, Sq, D)),
            "k_cache": _w((lambda *s: torch.randn(*s, dtype=torch.bfloat16) * 3.2)(B, Hkv, Sk, Dh)),
            "v_cache": _w((lambda *s: torch.randn(*s, dtype=torch.bfloat16) * 1.6)(B, Hkv, Sk, Dh)),
            "wq": _w((lambda *s: torch.randn(*s, dtype=torch.bfloat16) * 3.2)(D, Hq * Dh) * (D ** -0.5)),
            "wo": _w((lambda *s: torch.randn(*s, dtype=torch.bfloat16) * 1.6)(Hq * Dh, D) * ((Hq * Dh) ** -0.5)),
        }
    _A_in = _A_setup()

    def _B_setup():
        B, S, D, Dff = 1, 1, 448, 1792
        return {
            "x": _w((lambda *s: torch.randn(*s, dtype=torch.bfloat16) * 0.05)(B, S, D)),
            "w1": _w((lambda *s: torch.randn(*s, dtype=torch.bfloat16) * 0.05)(D, Dff)),
            "w2": _w((lambda *s: torch.randn(*s, dtype=torch.bfloat16) * 0.05)(Dff, D)),
        }
    _B_in = _B_setup()

    return {
        "A_x": _A_in["x"],
        "A_k_cache": _A_in["k_cache"],
        "A_v_cache": _A_in["v_cache"],
        "A_wq": _A_in["wq"],
        "A_wo": _A_in["wo"],
        "B_x": _B_in["x"],
        "B_w1": _B_in["w1"],
        "B_w2": _B_in["w2"],
    }

def reference(A_x, A_k_cache, A_v_cache, A_wq, A_wo, B_x, B_w1, B_w2):
    def _A_ref(x, k_cache, v_cache, wq, wo):
        B, Sq, D = x.shape
        Hq, Dh = 16, 256
        Hkv = k_cache.shape[1]
        rep = Hq // Hkv
        q = (lambda x, *d: x.permute(*d))((x @ wq).reshape(B, Sq, Hq, Dh), 0, 2, 1, 3)
        k = (lambda x, n, axis: torch.repeat_interleave(x, n, dim=axis))(k_cache, rep, axis=1)
        v = (lambda x, n, axis: torch.repeat_interleave(x, n, dim=axis))(v_cache, rep, axis=1)
        scores = torch.einsum("bhqd,bhkd->bhqk", q, k) * (Dh ** -0.5)
        p = _softmax(scores, axis=-1)
        o = torch.einsum("bhqk,bhkd->bhqd", p, v)
        return (lambda x, *d: x.permute(*d))(o, 0, 2, 1, 3).reshape(B, Sq, Hq * Dh) @ wo

    def _B_ref(x, w1, w2):
        h = torch.einsum("bsd,df->bsf", x, w1)
        zero = torch.zeros_like(h)
        h = torch.maximum(h, zero)
        return torch.einsum("bsf,fd->bsd", h, w2)

    x = A_x
    xn = _layernorm(x, axis=-1)
    return x + _A_ref(xn, A_k_cache, A_v_cache, A_wq, A_wo) + _B_ref(xn, B_w1, B_w2)
```

```asm
; @launch grid=(256,1,1) block=(768,1,1) lds=18432
.amdgcn_target "amdgcn-amd-amdhsa--gfx950"
.text
.globl parallel_sum__gqa_block_cached__dense_activation_relu__decode_kernel
.p2align 8
.type parallel_sum__gqa_block_cached__dense_activation_relu__decode_kernel,@function
parallel_sum__gqa_block_cached__dense_activation_relu__decode_kernel:
s_cmp_ge_u32 s2, 256
s_cbranch_scc1 L_end
s_load_dwordx16 s[4:19], s[0:1], 0
s_load_dwordx2 s[20:21], s[0:1], 64
s_load_dwordx2 s[22:23], s[0:1], 80
v_lshrrev_b32 v1, 6, v0
v_and_b32 v0, 63, v0
v_readfirstlane_b32 s3, v1
s_and_b32 s35, s2, 7
s_lshr_b32 s2, s2, 3
v_and_b32 v6, 7, v0
s_lshl_b32 s45, s35, 5
s_add_u32 s45, s45, s2
s_cmp_ge_u32 s3, 8
s_cbranch_scc1 L_helper
v_bfe_u32 v2, v0, 4, 1
v_lshlrev_b32 v2, 13, v2
v_bfe_u32 v3, v0, 3, 1
v_lshl_add_u32 v2, v3, 12, v2
v_lshrrev_b32 v3, 5, v0
v_lshl_add_u32 v2, v3, 11, v2
v_lshl_add_u32 v2, v6, 4, v2
s_and_b32 s33, s2, 7
s_lshl_b32 s33, s33, 21
s_lshl_b32 s32, s3, 14
s_or_b32 s33, s33, s32
s_bfe_u32 s32, s2, 65539
s_lshl_b32 s32, s32, 9
s_or_b32 s33, s33, s32
s_bfe_u32 s32, s2, 65540
s_lshl_b32 s32, s32, 10
s_or_b32 s33, s33, s32
s_bfe_u32 s44, s3, 65536
s_lshl_b32 s44, s44, 13
v_xor_b32 v2, s44, v2
s_or_b32 s44, s44, s33
s_lshl_b32 s32, s35, 24
s_mov_b32 s26, 0x1000000
s_mov_b32 s27, 0x20000
s_waitcnt lgkmcnt(0)
s_add_u32 s24, s6, s32
s_addc_u32 s25, s7, 0
s_mov_b64 vcc, 0
s_mov_b32 s40, 0
buffer_load_dwordx4 v[104:107], v2, s[24:27], s33 offen offset:0 nt
buffer_load_dwordx4 v[108:111], v2, s[24:27], s33 offen offset:128 nt
buffer_load_dwordx4 v[112:115], v2, s[24:27], s33 offen offset:256 nt
s_lshl_b32 s28, s35, 24
s_add_u32 s28, s8, s28
s_addc_u32 s29, s9, 0
s_mov_b32 s30, 0x1000000
s_mov_b32 s31, 0x20000
s_waitcnt vmcnt(1)
buffer_load_dwordx4 v[116:119], v2, s[24:27], s33 offen offset:384 nt
s_mov_b32 s6, 0x05040100
s_mov_b32 s7, 0x07060302
s_xor_b32 s32, s33, 131072
s_waitcnt vmcnt(2)
buffer_load_dwordx4 v[120:123], v2, s[24:27], s32 offen offset:0 nt
v_bfe_u32 v3, v0, 4, 1
v_lshlrev_b32 v3, 11, v3
v_lshrrev_b32 v4, 5, v0
v_lshl_add_u32 v3, v4, 12, v3
v_and_b32 v4, 15, v0
v_lshl_add_u32 v3, v4, 4, v3
s_waitcnt vmcnt(2)
buffer_load_dwordx4 v[124:127], v2, s[24:27], s32 offen offset:128 nt
s_lshl_b32 s9, s3, 6
v_add_u32 v1, s9, v0
s_waitcnt vmcnt(2)
buffer_load_dwordx4 v[128:131], v2, s[24:27], s32 offen offset:256 nt
v_mov_b32 v24, 0
v_mov_b32 v25, 0
v_mov_b32 v26, 0
v_mov_b32 v27, 0
v_mov_b32 v28, 0
v_mov_b32 v29, 0
v_mov_b32 v30, 0
v_mov_b32 v31, 0
v_mov_b32 v32, 0
v_mov_b32 v33, 0
v_mov_b32 v34, 0
v_mov_b32 v35, 0
v_mov_b32 v36, 0
v_mov_b32 v37, 0
v_mov_b32 v38, 0
v_mov_b32 v39, 0
s_waitcnt vmcnt(1)
buffer_load_dwordx4 v[132:135], v2, s[24:27], s32 offen offset:384 nt
v_bfe_u32 v5, v0, 3, 1
v_lshlrev_b32 v5, 9, v5
v_lshl_add_u32 v5, v6, 4, v5
v_mov_b32 v4, 0xff800000
s_xor_b32 s32, s33, 262144
s_waitcnt vmcnt(2)
buffer_load_dwordx4 v[136:139], v2, s[24:27], s32 offen offset:0 nt
s_waitcnt vmcnt(2)
buffer_load_dwordx4 v[140:143], v2, s[24:27], s32 offen offset:128 nt
s_waitcnt vmcnt(2)
buffer_load_dwordx4 v[144:147], v2, s[24:27], s32 offen offset:256 nt
s_waitcnt vmcnt(1)
buffer_load_dwordx4 v[148:151], v2, s[24:27], s32 offen offset:384 nt
s_xor_b32 s32, s33, 393216
s_waitcnt vmcnt(2)
buffer_load_dwordx4 v[152:155], v2, s[24:27], s32 offen offset:0 nt
s_waitcnt vmcnt(2)
buffer_load_dwordx4 v[156:159], v2, s[24:27], s32 offen offset:128 nt
s_waitcnt vmcnt(2)
buffer_load_dwordx4 v[160:163], v2, s[24:27], s32 offen offset:256 nt
s_waitcnt vmcnt(1)
buffer_load_dwordx4 v[164:167], v2, s[24:27], s32 offen offset:384 nt
s_xor_b32 s32, s33, 524288
s_waitcnt vmcnt(2)
buffer_load_dwordx4 v[60:63], v2, s[24:27], s32 offen offset:0 nt
s_waitcnt vmcnt(2)
buffer_load_dwordx4 v[64:67], v2, s[24:27], s32 offen offset:128 nt
s_waitcnt vmcnt(2)
buffer_load_dwordx4 v[68:71], v2, s[24:27], s32 offen offset:256 nt
s_waitcnt vmcnt(1)
buffer_load_dwordx4 v[72:75], v2, s[24:27], s32 offen offset:384 nt
s_mov_b64 exec, 1
v_mov_b32 v56, 0
v_mov_b32 v57, 1
ds_write_b32 v56, v57 offset:1364
s_mov_b64 exec, -1
s_xor_b32 s32, s33, 655360
s_waitcnt vmcnt(2)
buffer_load_dwordx4 v[76:79], v2, s[24:27], s32 offen offset:0 nt
s_waitcnt vmcnt(2)
buffer_load_dwordx4 v[80:83], v2, s[24:27], s32 offen offset:128 nt
s_waitcnt vmcnt(2)
buffer_load_dwordx4 v[84:87], v2, s[24:27], s32 offen offset:256 nt
s_waitcnt vmcnt(1)
buffer_load_dwordx4 v[88:91], v2, s[24:27], s32 offen offset:384 nt
s_xor_b32 s32, s33, 786432
s_waitcnt vmcnt(2)
buffer_load_dwordx4 v[92:95], v2, s[24:27], s32 offen offset:0 nt
s_waitcnt vmcnt(2)
buffer_load_dwordx4 v[96:99], v2, s[24:27], s32 offen offset:128 nt
s_waitcnt vmcnt(2)
buffer_load_dwordx4 v[100:103], v2, s[24:27], s32 offen offset:256 nt
s_barrier
s_mov_b32 exec_lo, 0x0000ffff
s_mov_b32 exec_hi, 0xffff0000
ds_read_b128 v[24:27], v5 offset:0
ds_read_b128 v[28:31], v5 offset:128
ds_read_b128 v[32:35], v5 offset:256
ds_read_b128 v[36:39], v5 offset:384
s_mov_b64 exec, -1
s_waitcnt lgkmcnt(0)
v_mfma_f32_32x32x16_bf16 v[40:55], v[104:107], v[24:27], 0
v_mfma_f32_32x32x16_bf16 v[40:55], v[108:111], v[28:31], v[40:55]
v_mfma_f32_32x32x16_bf16 v[40:55], v[112:115], v[32:35], v[40:55]
v_mfma_f32_32x32x16_bf16 v[40:55], v[116:119], v[36:39], v[40:55]
s_waitcnt vmcnt(1)
buffer_load_dwordx4 v[104:107], v2, s[24:27], s32 offen offset:384 nt
s_nop 11
v_add_f32_dpp v56, v41, v40 quad_perm:[1,1,1,1] row_mask:0xf bank_mask:0xf
v_add_f32_dpp v57, v45, v44 quad_perm:[1,1,1,1] row_mask:0xf bank_mask:0xf
v_add_f32_dpp v58, v49, v48 quad_perm:[1,1,1,1] row_mask:0xf bank_mask:0xf
v_add_f32_dpp v59, v53, v52 quad_perm:[1,1,1,1] row_mask:0xf bank_mask:0xf
v_add_f32_dpp v56, v42, v56 quad_perm:[2,2,2,2] row_mask:0xf bank_mask:0xf
v_add_f32_dpp v57, v46, v57 quad_perm:[2,2,2,2] row_mask:0xf bank_mask:0xf
v_add_f32_dpp v58, v50, v58 quad_perm:[2,2,2,2] row_mask:0xf bank_mask:0xf
v_add_f32_dpp v59, v54, v59 quad_perm:[2,2,2,2] row_mask:0xf bank_mask:0xf
v_add_f32_dpp v56, v43, v56 quad_perm:[3,3,3,3] row_mask:0xf bank_mask:0xf
v_add_f32_dpp v57, v47, v57 quad_perm:[3,3,3,3] row_mask:0xf bank_mask:0xf
v_add_f32_dpp v58, v51, v58 quad_perm:[3,3,3,3] row_mask:0xf bank_mask:0xf
v_add_f32_dpp v59, v55, v59 quad_perm:[3,3,3,3] row_mask:0xf bank_mask:0xf
s_nop 1
v_permlane32_swap_b32 v56, v57
v_permlane32_swap_b32 v58, v59
s_nop 0
v_add_f32_dpp v56, v57, v56 row_shl:4 row_mask:0xf bank_mask:0xf bound_ctrl:0
v_add_f32_dpp v58, v59, v58 row_shl:4 row_mask:0xf bank_mask:0xf bound_ctrl:0
v_max3_f32 v4, v56, v58, v4
v_cvt_pk_bf16_f32 v8, v56, v58
s_xor_b32 s32, s33, 917504
s_waitcnt vmcnt(2)
buffer_load_dwordx4 v[108:111], v2, s[24:27], s32 offen offset:0 nt
s_mov_b64 exec, 1
v_mov_b32 v6, 2
ds_add_u32 v0, v6 offset:1352
s_mov_b64 exec, -1
v_mfma_f32_32x32x16_bf16 v[40:55], v[120:123], v[24:27], 0
v_mfma_f32_32x32x16_bf16 v[40:55], v[124:127], v[28:31], v[40:55]
v_mfma_f32_32x32x16_bf16 v[40:55], v[128:131], v[32:35], v[40:55]
v_mfma_f32_32x32x16_bf16 v[40:55], v[132:135], v[36:39], v[40:55]
s_waitcnt vmcnt(2)
buffer_load_dwordx4 v[112:115], v2, s[24:27], s32 offen offset:128 nt
v_mov_b32 v6, 0
ds_read_b32 v6, v6 offset:1356
s_waitcnt lgkmcnt(0)
v_cmp_eq_u32 vcc, 1, v6
s_nop 11
v_add_f32_dpp v56, v41, v40 quad_perm:[1,1,1,1] row_mask:0xf bank_mask:0xf
v_add_f32_dpp v57, v45, v44 quad_perm:[1,1,1,1] row_mask:0xf bank_mask:0xf
v_add_f32_dpp v58, v49, v48 quad_perm:[1,1,1,1] row_mask:0xf bank_mask:0xf
v_add_f32_dpp v59, v53, v52 quad_perm:[1,1,1,1] row_mask:0xf bank_mask:0xf
v_add_f32_dpp v56, v42, v56 quad_perm:[2,2,2,2] row_mask:0xf bank_mask:0xf
v_add_f32_dpp v57, v46, v57 quad_perm:[2,2,2,2] row_mask:0xf bank_mask:0xf
v_add_f32_dpp v58, v50, v58 quad_perm:[2,2,2,2] row_mask:0xf bank_mask:0xf
v_add_f32_dpp v59, v54, v59 quad_perm:[2,2,2,2] row_mask:0xf bank_mask:0xf
v_add_f32_dpp v56, v43, v56 quad_perm:[3,3,3,3] row_mask:0xf bank_mask:0xf
v_add_f32_dpp v57, v47, v57 quad_perm:[3,3,3,3] row_mask:0xf bank_mask:0xf
v_add_f32_dpp v58, v51, v58 quad_perm:[3,3,3,3] row_mask:0xf bank_mask:0xf
v_add_f32_dpp v59, v55, v59 quad_perm:[3,3,3,3] row_mask:0xf bank_mask:0xf
s_nop 1
v_permlane32_swap_b32 v56, v57
v_permlane32_swap_b32 v58, v59
s_nop 0
v_add_f32_dpp v56, v57, v56 row_shl:4 row_mask:0xf bank_mask:0xf bound_ctrl:0
v_add_f32_dpp v58, v59, v58 row_shl:4 row_mask:0xf bank_mask:0xf bound_ctrl:0
v_max3_f32 v4, v56, v58, v4
v_cvt_pk_bf16_f32 v9, v56, v58
s_waitcnt vmcnt(2)
buffer_load_dwordx4 v[116:119], v2, s[24:27], s32 offen offset:256 nt
s_mov_b64 exec, 1
v_mov_b32 v6, 2
ds_add_u32 v0, v6 offset:1352
s_mov_b64 exec, -1
v_mfma_f32_32x32x16_bf16 v[40:55], v[136:139], v[24:27], 0
v_mfma_f32_32x32x16_bf16 v[40:55], v[140:143], v[28:31], v[40:55]
v_mfma_f32_32x32x16_bf16 v[40:55], v[144:147], v[32:35], v[40:55]
v_mfma_f32_32x32x16_bf16 v[40:55], v[148:151], v[36:39], v[40:55]
s_waitcnt vmcnt(2)
s_cbranch_vccnz L_w31
s_waitcnt vmcnt(1)
L_w31:
buffer_load_dwordx4 v[120:123], v2, s[24:27], s32 offen offset:384 nt
s_nop 11
v_add_f32_dpp v56, v41, v40 quad_perm:[1,1,1,1] row_mask:0xf bank_mask:0xf
v_add_f32_dpp v57, v45, v44 quad_perm:[1,1,1,1] row_mask:0xf bank_mask:0xf
v_add_f32_dpp v58, v49, v48 quad_perm:[1,1,1,1] row_mask:0xf bank_mask:0xf
v_add_f32_dpp v59, v53, v52 quad_perm:[1,1,1,1] row_mask:0xf bank_mask:0xf
v_add_f32_dpp v56, v42, v56 quad_perm:[2,2,2,2] row_mask:0xf bank_mask:0xf
v_add_f32_dpp v57, v46, v57 quad_perm:[2,2,2,2] row_mask:0xf bank_mask:0xf
v_add_f32_dpp v58, v50, v58 quad_perm:[2,2,2,2] row_mask:0xf bank_mask:0xf
v_add_f32_dpp v59, v54, v59 quad_perm:[2,2,2,2] row_mask:0xf bank_mask:0xf
v_add_f32_dpp v56, v43, v56 quad_perm:[3,3,3,3] row_mask:0xf bank_mask:0xf
v_add_f32_dpp v57, v47, v57 quad_perm:[3,3,3,3] row_mask:0xf bank_mask:0xf
v_add_f32_dpp v58, v51, v58 quad_perm:[3,3,3,3] row_mask:0xf bank_mask:0xf
v_add_f32_dpp v59, v55, v59 quad_perm:[3,3,3,3] row_mask:0xf bank_mask:0xf
s_nop 1
v_permlane32_swap_b32 v56, v57
v_permlane32_swap_b32 v58, v59
s_nop 0
v_add_f32_dpp v56, v57, v56 row_shl:4 row_mask:0xf bank_mask:0xf bound_ctrl:0
v_add_f32_dpp v58, v59, v58 row_shl:4 row_mask:0xf bank_mask:0xf bound_ctrl:0
v_max3_f32 v4, v56, v58, v4
v_cvt_pk_bf16_f32 v10, v56, v58
s_xor_b32 s32, s33, 1048576
s_waitcnt vmcnt(2)
buffer_load_dwordx4 v[124:127], v2, s[24:27], s32 offen offset:0 nt
s_mov_b64 exec, 1
v_mov_b32 v6, 2
ds_add_u32 v0, v6 offset:1352
s_mov_b64 exec, -1
v_mfma_f32_32x32x16_bf16 v[40:55], v[152:155], v[24:27], 0
v_mfma_f32_32x32x16_bf16 v[40:55], v[156:159], v[28:31], v[40:55]
v_mfma_f32_32x32x16_bf16 v[40:55], v[160:163], v[32:35], v[40:55]
v_mfma_f32_32x32x16_bf16 v[40:55], v[164:167], v[36:39], v[40:55]
s_waitcnt vmcnt(2)
buffer_load_dwordx4 v[128:131], v2, s[24:27], s32 offen offset:128 nt
v_mov_b32 v6, 0
ds_read_b32 v6, v6 offset:1356
s_waitcnt lgkmcnt(0)
v_cmp_eq_u32 vcc, 1, v6
s_nop 11
v_add_f32_dpp v56, v41, v40 quad_perm:[1,1,1,1] row_mask:0xf bank_mask:0xf
v_add_f32_dpp v57, v45, v44 quad_perm:[1,1,1,1] row_mask:0xf bank_mask:0xf
v_add_f32_dpp v58, v49, v48 quad_perm:[1,1,1,1] row_mask:0xf bank_mask:0xf
v_add_f32_dpp v59, v53, v52 quad_perm:[1,1,1,1] row_mask:0xf bank_mask:0xf
v_add_f32_dpp v56, v42, v56 quad_perm:[2,2,2,2] row_mask:0xf bank_mask:0xf
v_add_f32_dpp v57, v46, v57 quad_perm:[2,2,2,2] row_mask:0xf bank_mask:0xf
v_add_f32_dpp v58, v50, v58 quad_perm:[2,2,2,2] row_mask:0xf bank_mask:0xf
v_add_f32_dpp v59, v54, v59 quad_perm:[2,2,2,2] row_mask:0xf bank_mask:0xf
v_add_f32_dpp v56, v43, v56 quad_perm:[3,3,3,3] row_mask:0xf bank_mask:0xf
v_add_f32_dpp v57, v47, v57 quad_perm:[3,3,3,3] row_mask:0xf bank_mask:0xf
v_add_f32_dpp v58, v51, v58 quad_perm:[3,3,3,3] row_mask:0xf bank_mask:0xf
v_add_f32_dpp v59, v55, v59 quad_perm:[3,3,3,3] row_mask:0xf bank_mask:0xf
s_nop 1
v_permlane32_swap_b32 v56, v57
v_permlane32_swap_b32 v58, v59
s_nop 0
v_add_f32_dpp v56, v57, v56 row_shl:4 row_mask:0xf bank_mask:0xf bound_ctrl:0
v_add_f32_dpp v58, v59, v58 row_shl:4 row_mask:0xf bank_mask:0xf bound_ctrl:0
v_max3_f32 v4, v56, v58, v4
v_cvt_pk_bf16_f32 v11, v56, v58
s_waitcnt vmcnt(2)
buffer_load_dwordx4 v[132:135], v2, s[24:27], s32 offen offset:256 nt
s_mov_b64 exec, 1
v_mov_b32 v6, 2
ds_add_u32 v0, v6 offset:1352
s_mov_b64 exec, -1
v_mfma_f32_32x32x16_bf16 v[40:55], v[60:63], v[24:27], 0
v_mfma_f32_32x32x16_bf16 v[40:55], v[64:67], v[28:31], v[40:55]
v_mfma_f32_32x32x16_bf16 v[40:55], v[68:71], v[32:35], v[40:55]
v_mfma_f32_32x32x16_bf16 v[40:55], v[72:75], v[36:39], v[40:55]
s_waitcnt vmcnt(2)
s_cbranch_vccnz L_w35
s_waitcnt vmcnt(1)
L_w35:
buffer_load_dwordx4 v[136:139], v2, s[24:27], s32 offen offset:384 nt
s_nop 11
v_add_f32_dpp v56, v41, v40 quad_perm:[1,1,1,1] row_mask:0xf bank_mask:0xf
v_add_f32_dpp v57, v45, v44 quad_perm:[1,1,1,1] row_mask:0xf bank_mask:0xf
v_add_f32_dpp v58, v49, v48 quad_perm:[1,1,1,1] row_mask:0xf bank_mask:0xf
v_add_f32_dpp v59, v53, v52 quad_perm:[1,1,1,1] row_mask:0xf bank_mask:0xf
v_add_f32_dpp v56, v42, v56 quad_perm:[2,2,2,2] row_mask:0xf bank_mask:0xf
v_add_f32_dpp v57, v46, v57 quad_perm:[2,2,2,2] row_mask:0xf bank_mask:0xf
v_add_f32_dpp v58, v50, v58 quad_perm:[2,2,2,2] row_mask:0xf bank_mask:0xf
v_add_f32_dpp v59, v54, v59 quad_perm:[2,2,2,2] row_mask:0xf bank_mask:0xf
v_add_f32_dpp v56, v43, v56 quad_perm:[3,3,3,3] row_mask:0xf bank_mask:0xf
v_add_f32_dpp v57, v47, v57 quad_perm:[3,3,3,3] row_mask:0xf bank_mask:0xf
v_add_f32_dpp v58, v51, v58 quad_perm:[3,3,3,3] row_mask:0xf bank_mask:0xf
v_add_f32_dpp v59, v55, v59 quad_perm:[3,3,3,3] row_mask:0xf bank_mask:0xf
s_nop 1
v_permlane32_swap_b32 v56, v57
v_permlane32_swap_b32 v58, v59
s_nop 0
v_add_f32_dpp v56, v57, v56 row_shl:4 row_mask:0xf bank_mask:0xf bound_ctrl:0
v_add_f32_dpp v58, v59, v58 row_shl:4 row_mask:0xf bank_mask:0xf bound_ctrl:0
v_max3_f32 v4, v56, v58, v4
v_cvt_pk_bf16_f32 v12, v56, v58
s_xor_b32 s32, s33, 1179648
s_waitcnt vmcnt(2)
buffer_load_dwordx4 v[140:143], v2, s[24:27], s32 offen offset:0 nt
s_mov_b64 exec, 1
v_mov_b32 v6, 2
ds_add_u32 v0, v6 offset:1352
s_mov_b64 exec, -1
v_mfma_f32_32x32x16_bf16 v[40:55], v[76:79], v[24:27], 0
v_mfma_f32_32x32x16_bf16 v[40:55], v[80:83], v[28:31], v[40:55]
v_mfma_f32_32x32x16_bf16 v[40:55], v[84:87], v[32:35], v[40:55]
v_mfma_f32_32x32x16_bf16 v[40:55], v[88:91], v[36:39], v[40:55]
s_waitcnt vmcnt(2)
buffer_load_dwordx4 v[144:147], v2, s[24:27], s32 offen offset:128 nt
v_mov_b32 v6, 0
ds_read_b32 v6, v6 offset:1356
s_waitcnt lgkmcnt(0)
v_cmp_eq_u32 vcc, 1, v6
s_nop 11
v_add_f32_dpp v56, v41, v40 quad_perm:[1,1,1,1] row_mask:0xf bank_mask:0xf
v_add_f32_dpp v57, v45, v44 quad_perm:[1,1,1,1] row_mask:0xf bank_mask:0xf
v_add_f32_dpp v58, v49, v48 quad_perm:[1,1,1,1] row_mask:0xf bank_mask:0xf
v_add_f32_dpp v59, v53, v52 quad_perm:[1,1,1,1] row_mask:0xf bank_mask:0xf
v_add_f32_dpp v56, v42, v56 quad_perm:[2,2,2,2] row_mask:0xf bank_mask:0xf
v_add_f32_dpp v57, v46, v57 quad_perm:[2,2,2,2] row_mask:0xf bank_mask:0xf
v_add_f32_dpp v58, v50, v58 quad_perm:[2,2,2,2] row_mask:0xf bank_mask:0xf
v_add_f32_dpp v59, v54, v59 quad_perm:[2,2,2,2] row_mask:0xf bank_mask:0xf
v_add_f32_dpp v56, v43, v56 quad_perm:[3,3,3,3] row_mask:0xf bank_mask:0xf
v_add_f32_dpp v57, v47, v57 quad_perm:[3,3,3,3] row_mask:0xf bank_mask:0xf
v_add_f32_dpp v58, v51, v58 quad_perm:[3,3,3,3] row_mask:0xf bank_mask:0xf
v_add_f32_dpp v59, v55, v59 quad_perm:[3,3,3,3] row_mask:0xf bank_mask:0xf
s_nop 1
v_permlane32_swap_b32 v56, v57
v_permlane32_swap_b32 v58, v59
s_nop 0
v_add_f32_dpp v56, v57, v56 row_shl:4 row_mask:0xf bank_mask:0xf bound_ctrl:0
v_add_f32_dpp v58, v59, v58 row_shl:4 row_mask:0xf bank_mask:0xf bound_ctrl:0
v_max3_f32 v4, v56, v58, v4
v_cvt_pk_bf16_f32 v13, v56, v58
s_waitcnt vmcnt(2)
buffer_load_dwordx4 v[148:151], v2, s[24:27], s32 offen offset:256 nt
s_mov_b64 exec, 1
v_mov_b32 v6, 2
ds_add_u32 v0, v6 offset:1352
s_mov_b64 exec, -1
v_mfma_f32_32x32x16_bf16 v[40:55], v[92:95], v[24:27], 0
v_mfma_f32_32x32x16_bf16 v[40:55], v[96:99], v[28:31], v[40:55]
v_mfma_f32_32x32x16_bf16 v[40:55], v[100:103], v[32:35], v[40:55]
v_mfma_f32_32x32x16_bf16 v[40:55], v[104:107], v[36:39], v[40:55]
s_waitcnt vmcnt(2)
s_cbranch_vccnz L_w39
s_waitcnt vmcnt(1)
L_w39:
buffer_load_dwordx4 v[152:155], v2, s[24:27], s32 offen offset:384 nt
s_nop 11
v_add_f32_dpp v56, v41, v40 quad_perm:[1,1,1,1] row_mask:0xf bank_mask:0xf
v_add_f32_dpp v57, v45, v44 quad_perm:[1,1,1,1] row_mask:0xf bank_mask:0xf
v_add_f32_dpp v58, v49, v48 quad_perm:[1,1,1,1] row_mask:0xf bank_mask:0xf
v_add_f32_dpp v59, v53, v52 quad_perm:[1,1,1,1] row_mask:0xf bank_mask:0xf
v_add_f32_dpp v56, v42, v56 quad_perm:[2,2,2,2] row_mask:0xf bank_mask:0xf
v_add_f32_dpp v57, v46, v57 quad_perm:[2,2,2,2] row_mask:0xf bank_mask:0xf
v_add_f32_dpp v58, v50, v58 quad_perm:[2,2,2,2] row_mask:0xf bank_mask:0xf
v_add_f32_dpp v59, v54, v59 quad_perm:[2,2,2,2] row_mask:0xf bank_mask:0xf
v_add_f32_dpp v56, v43, v56 quad_perm:[3,3,3,3] row_mask:0xf bank_mask:0xf
v_add_f32_dpp v57, v47, v57 quad_perm:[3,3,3,3] row_mask:0xf bank_mask:0xf
v_add_f32_dpp v58, v51, v58 quad_perm:[3,3,3,3] row_mask:0xf bank_mask:0xf
v_add_f32_dpp v59, v55, v59 quad_perm:[3,3,3,3] row_mask:0xf bank_mask:0xf
s_nop 1
v_permlane32_swap_b32 v56, v57
v_permlane32_swap_b32 v58, v59
s_nop 0
v_add_f32_dpp v56, v57, v56 row_shl:4 row_mask:0xf bank_mask:0xf bound_ctrl:0
v_add_f32_dpp v58, v59, v58 row_shl:4 row_mask:0xf bank_mask:0xf bound_ctrl:0
v_max3_f32 v4, v56, v58, v4
v_cvt_pk_bf16_f32 v14, v56, v58
s_xor_b32 s32, s33, 1310720
s_waitcnt vmcnt(2)
buffer_load_dwordx4 v[156:159], v2, s[24:27], s32 offen offset:0 nt
s_mov_b64 exec, 1
v_mov_b32 v6, 2
ds_add_u32 v0, v6 offset:1352
s_mov_b64 exec, -1
v_mfma_f32_32x32x16_bf16 v[40:55], v[108:111], v[24:27], 0
v_mfma_f32_32x32x16_bf16 v[40:55], v[112:115], v[28:31], v[40:55]
v_mfma_f32_32x32x16_bf16 v[40:55], v[116:119], v[32:35], v[40:55]
v_mfma_f32_32x32x16_bf16 v[40:55], v[120:123], v[36:39], v[40:55]
s_waitcnt vmcnt(2)
buffer_load_dwordx4 v[160:163], v2, s[24:27], s32 offen offset:128 nt
v_mov_b32 v6, 0
ds_read_b32 v6, v6 offset:1356
s_waitcnt lgkmcnt(0)
v_cmp_eq_u32 vcc, 1, v6
s_nop 11
v_add_f32_dpp v56, v41, v40 quad_perm:[1,1,1,1] row_mask:0xf bank_mask:0xf
v_add_f32_dpp v57, v45, v44 quad_perm:[1,1,1,1] row_mask:0xf bank_mask:0xf
v_add_f32_dpp v58, v49, v48 quad_perm:[1,1,1,1] row_mask:0xf bank_mask:0xf
v_add_f32_dpp v59, v53, v52 quad_perm:[1,1,1,1] row_mask:0xf bank_mask:0xf
v_add_f32_dpp v56, v42, v56 quad_perm:[2,2,2,2] row_mask:0xf bank_mask:0xf
v_add_f32_dpp v57, v46, v57 quad_perm:[2,2,2,2] row_mask:0xf bank_mask:0xf
v_add_f32_dpp v58, v50, v58 quad_perm:[2,2,2,2] row_mask:0xf bank_mask:0xf
v_add_f32_dpp v59, v54, v59 quad_perm:[2,2,2,2] row_mask:0xf bank_mask:0xf
v_add_f32_dpp v56, v43, v56 quad_perm:[3,3,3,3] row_mask:0xf bank_mask:0xf
v_add_f32_dpp v57, v47, v57 quad_perm:[3,3,3,3] row_mask:0xf bank_mask:0xf
v_add_f32_dpp v58, v51, v58 quad_perm:[3,3,3,3] row_mask:0xf bank_mask:0xf
v_add_f32_dpp v59, v55, v59 quad_perm:[3,3,3,3] row_mask:0xf bank_mask:0xf
s_nop 1
v_permlane32_swap_b32 v56, v57
v_permlane32_swap_b32 v58, v59
s_nop 0
v_add_f32_dpp v56, v57, v56 row_shl:4 row_mask:0xf bank_mask:0xf bound_ctrl:0
v_add_f32_dpp v58, v59, v58 row_shl:4 row_mask:0xf bank_mask:0xf bound_ctrl:0
v_max3_f32 v4, v56, v58, v4
v_cvt_pk_bf16_f32 v15, v56, v58
s_waitcnt vmcnt(2)
buffer_load_dwordx4 v[164:167], v2, s[24:27], s32 offen offset:256 nt
s_mov_b64 exec, 1
v_mov_b32 v6, 2
ds_add_u32 v0, v6 offset:1352
s_mov_b64 exec, -1
v_mfma_f32_32x32x16_bf16 v[40:55], v[124:127], v[24:27], 0
v_mfma_f32_32x32x16_bf16 v[40:55], v[128:131], v[28:31], v[40:55]
v_mfma_f32_32x32x16_bf16 v[40:55], v[132:135], v[32:35], v[40:55]
v_mfma_f32_32x32x16_bf16 v[40:55], v[136:139], v[36:39], v[40:55]
s_waitcnt vmcnt(2)
s_cbranch_vccnz L_w43
s_waitcnt vmcnt(1)
L_w43:
buffer_load_dwordx4 v[104:107], v2, s[24:27], s32 offen offset:384 nt
s_nop 11
v_add_f32_dpp v56, v41, v40 quad_perm:[1,1,1,1] row_mask:0xf bank_mask:0xf
v_add_f32_dpp v57, v45, v44 quad_perm:[1,1,1,1] row_mask:0xf bank_mask:0xf
v_add_f32_dpp v58, v49, v48 quad_perm:[1,1,1,1] row_mask:0xf bank_mask:0xf
v_add_f32_dpp v59, v53, v52 quad_perm:[1,1,1,1] row_mask:0xf bank_mask:0xf
v_add_f32_dpp v56, v42, v56 quad_perm:[2,2,2,2] row_mask:0xf bank_mask:0xf
v_add_f32_dpp v57, v46, v57 quad_perm:[2,2,2,2] row_mask:0xf bank_mask:0xf
v_add_f32_dpp v58, v50, v58 quad_perm:[2,2,2,2] row_mask:0xf bank_mask:0xf
v_add_f32_dpp v59, v54, v59 quad_perm:[2,2,2,2] row_mask:0xf bank_mask:0xf
v_add_f32_dpp v56, v43, v56 quad_perm:[3,3,3,3] row_mask:0xf bank_mask:0xf
v_add_f32_dpp v57, v47, v57 quad_perm:[3,3,3,3] row_mask:0xf bank_mask:0xf
v_add_f32_dpp v58, v51, v58 quad_perm:[3,3,3,3] row_mask:0xf bank_mask:0xf
v_add_f32_dpp v59, v55, v59 quad_perm:[3,3,3,3] row_mask:0xf bank_mask:0xf
s_nop 1
v_permlane32_swap_b32 v56, v57
v_permlane32_swap_b32 v58, v59
s_nop 0
v_add_f32_dpp v56, v57, v56 row_shl:4 row_mask:0xf bank_mask:0xf bound_ctrl:0
v_add_f32_dpp v58, v59, v58 row_shl:4 row_mask:0xf bank_mask:0xf bound_ctrl:0
v_max3_f32 v4, v56, v58, v4
v_cvt_pk_bf16_f32 v16, v56, v58
s_xor_b32 s32, s33, 1441792
s_waitcnt vmcnt(2)
buffer_load_dwordx4 v[108:111], v2, s[24:27], s32 offen offset:0 nt
s_mov_b64 exec, 1
v_mov_b32 v6, 2
ds_add_u32 v0, v6 offset:1352
s_mov_b64 exec, -1
v_mfma_f32_32x32x16_bf16 v[40:55], v[140:143], v[24:27], 0
v_mfma_f32_32x32x16_bf16 v[40:55], v[144:147], v[28:31], v[40:55]
v_mfma_f32_32x32x16_bf16 v[40:55], v[148:151], v[32:35], v[40:55]
v_mfma_f32_32x32x16_bf16 v[40:55], v[152:155], v[36:39], v[40:55]
s_waitcnt vmcnt(2)
buffer_load_dwordx4 v[112:115], v2, s[24:27], s32 offen offset:128 nt
v_mov_b32 v6, 0
ds_read_b32 v6, v6 offset:1356
s_waitcnt lgkmcnt(0)
v_cmp_eq_u32 vcc, 1, v6
s_nop 11
v_add_f32_dpp v56, v41, v40 quad_perm:[1,1,1,1] row_mask:0xf bank_mask:0xf
v_add_f32_dpp v57, v45, v44 quad_perm:[1,1,1,1] row_mask:0xf bank_mask:0xf
v_add_f32_dpp v58, v49, v48 quad_perm:[1,1,1,1] row_mask:0xf bank_mask:0xf
v_add_f32_dpp v59, v53, v52 quad_perm:[1,1,1,1] row_mask:0xf bank_mask:0xf
v_add_f32_dpp v56, v42, v56 quad_perm:[2,2,2,2] row_mask:0xf bank_mask:0xf
v_add_f32_dpp v57, v46, v57 quad_perm:[2,2,2,2] row_mask:0xf bank_mask:0xf
v_add_f32_dpp v58, v50, v58 quad_perm:[2,2,2,2] row_mask:0xf bank_mask:0xf
v_add_f32_dpp v59, v54, v59 quad_perm:[2,2,2,2] row_mask:0xf bank_mask:0xf
v_add_f32_dpp v56, v43, v56 quad_perm:[3,3,3,3] row_mask:0xf bank_mask:0xf
v_add_f32_dpp v57, v47, v57 quad_perm:[3,3,3,3] row_mask:0xf bank_mask:0xf
v_add_f32_dpp v58, v51, v58 quad_perm:[3,3,3,3] row_mask:0xf bank_mask:0xf
v_add_f32_dpp v59, v55, v59 quad_perm:[3,3,3,3] row_mask:0xf bank_mask:0xf
s_nop 1
v_permlane32_swap_b32 v56, v57
v_permlane32_swap_b32 v58, v59
s_nop 0
v_add_f32_dpp v56, v57, v56 row_shl:4 row_mask:0xf bank_mask:0xf bound_ctrl:0
v_add_f32_dpp v58, v59, v58 row_shl:4 row_mask:0xf bank_mask:0xf bound_ctrl:0
v_max3_f32 v4, v56, v58, v4
v_cvt_pk_bf16_f32 v17, v56, v58
s_waitcnt vmcnt(2)
buffer_load_dwordx4 v[116:119], v2, s[24:27], s32 offen offset:256 nt
s_mov_b64 exec, 1
v_mov_b32 v6, 2
ds_add_u32 v0, v6 offset:1352
s_mov_b64 exec, -1
v_mfma_f32_32x32x16_bf16 v[40:55], v[156:159], v[24:27], 0
v_mfma_f32_32x32x16_bf16 v[40:55], v[160:163], v[28:31], v[40:55]
v_mfma_f32_32x32x16_bf16 v[40:55], v[164:167], v[32:35], v[40:55]
v_mfma_f32_32x32x16_bf16 v[40:55], v[104:107], v[36:39], v[40:55]
s_waitcnt vmcnt(2)
s_cbranch_vccnz L_w47
s_waitcnt vmcnt(1)
L_w47:
buffer_load_dwordx4 v[120:123], v2, s[24:27], s32 offen offset:384 nt
s_nop 11
v_add_f32_dpp v56, v41, v40 quad_perm:[1,1,1,1] row_mask:0xf bank_mask:0xf
v_add_f32_dpp v57, v45, v44 quad_perm:[1,1,1,1] row_mask:0xf bank_mask:0xf
v_add_f32_dpp v58, v49, v48 quad_perm:[1,1,1,1] row_mask:0xf bank_mask:0xf
v_add_f32_dpp v59, v53, v52 quad_perm:[1,1,1,1] row_mask:0xf bank_mask:0xf
v_add_f32_dpp v56, v42, v56 quad_perm:[2,2,2,2] row_mask:0xf bank_mask:0xf
v_add_f32_dpp v57, v46, v57 quad_perm:[2,2,2,2] row_mask:0xf bank_mask:0xf
v_add_f32_dpp v58, v50, v58 quad_perm:[2,2,2,2] row_mask:0xf bank_mask:0xf
v_add_f32_dpp v59, v54, v59 quad_perm:[2,2,2,2] row_mask:0xf bank_mask:0xf
v_add_f32_dpp v56, v43, v56 quad_perm:[3,3,3,3] row_mask:0xf bank_mask:0xf
v_add_f32_dpp v57, v47, v57 quad_perm:[3,3,3,3] row_mask:0xf bank_mask:0xf
v_add_f32_dpp v58, v51, v58 quad_perm:[3,3,3,3] row_mask:0xf bank_mask:0xf
v_add_f32_dpp v59, v55, v59 quad_perm:[3,3,3,3] row_mask:0xf bank_mask:0xf
s_nop 1
v_permlane32_swap_b32 v56, v57
v_permlane32_swap_b32 v58, v59
s_nop 0
v_add_f32_dpp v56, v57, v56 row_shl:4 row_mask:0xf bank_mask:0xf bound_ctrl:0
v_add_f32_dpp v58, v59, v58 row_shl:4 row_mask:0xf bank_mask:0xf bound_ctrl:0
v_max3_f32 v4, v56, v58, v4
v_cvt_pk_bf16_f32 v18, v56, v58
s_xor_b32 s32, s33, 1572864
s_waitcnt vmcnt(2)
buffer_load_dwordx4 v[60:63], v2, s[24:27], s32 offen offset:0 nt
s_mov_b64 exec, 1
v_mov_b32 v6, 2
ds_add_u32 v0, v6 offset:1352
s_mov_b64 exec, -1
s_waitcnt vmcnt(2)
buffer_load_dwordx4 v[64:67], v2, s[24:27], s32 offen offset:128 nt
v_mov_b32 v6, 0
ds_read_b32 v6, v6 offset:1356
s_waitcnt lgkmcnt(0)
v_cmp_eq_u32 vcc, 1, v6
s_waitcnt vmcnt(2)
buffer_load_dwordx4 v[68:71], v2, s[24:27], s32 offen offset:256 nt
s_mov_b64 exec, 1
v_mov_b32 v6, 2
ds_add_u32 v0, v6 offset:1352
s_mov_b64 exec, -1
v_mfma_f32_32x32x16_bf16 v[40:55], v[108:111], v[24:27], 0
v_mfma_f32_32x32x16_bf16 v[40:55], v[112:115], v[28:31], v[40:55]
v_mfma_f32_32x32x16_bf16 v[40:55], v[116:119], v[32:35], v[40:55]
v_mfma_f32_32x32x16_bf16 v[40:55], v[120:123], v[36:39], v[40:55]
s_waitcnt vmcnt(2)
s_cbranch_vccnz L_w51
s_waitcnt vmcnt(1)
L_w51:
buffer_load_dwordx4 v[72:75], v2, s[24:27], s32 offen offset:384 nt
s_nop 11
v_add_f32_dpp v56, v41, v40 quad_perm:[1,1,1,1] row_mask:0xf bank_mask:0xf
v_add_f32_dpp v57, v45, v44 quad_perm:[1,1,1,1] row_mask:0xf bank_mask:0xf
v_add_f32_dpp v58, v49, v48 quad_perm:[1,1,1,1] row_mask:0xf bank_mask:0xf
v_add_f32_dpp v59, v53, v52 quad_perm:[1,1,1,1] row_mask:0xf bank_mask:0xf
v_add_f32_dpp v56, v42, v56 quad_perm:[2,2,2,2] row_mask:0xf bank_mask:0xf
v_add_f32_dpp v57, v46, v57 quad_perm:[2,2,2,2] row_mask:0xf bank_mask:0xf
v_add_f32_dpp v58, v50, v58 quad_perm:[2,2,2,2] row_mask:0xf bank_mask:0xf
v_add_f32_dpp v59, v54, v59 quad_perm:[2,2,2,2] row_mask:0xf bank_mask:0xf
v_add_f32_dpp v56, v43, v56 quad_perm:[3,3,3,3] row_mask:0xf bank_mask:0xf
v_add_f32_dpp v57, v47, v57 quad_perm:[3,3,3,3] row_mask:0xf bank_mask:0xf
v_add_f32_dpp v58, v51, v58 quad_perm:[3,3,3,3] row_mask:0xf bank_mask:0xf
v_add_f32_dpp v59, v55, v59 quad_perm:[3,3,3,3] row_mask:0xf bank_mask:0xf
s_nop 1
v_permlane32_swap_b32 v56, v57
v_permlane32_swap_b32 v58, v59
s_nop 0
v_add_f32_dpp v56, v57, v56 row_shl:4 row_mask:0xf bank_mask:0xf bound_ctrl:0
v_add_f32_dpp v58, v59, v58 row_shl:4 row_mask:0xf bank_mask:0xf bound_ctrl:0
v_max3_f32 v4, v56, v58, v4
v_cvt_pk_bf16_f32 v19, v56, v58
s_xor_b32 s32, s33, 1703936
s_waitcnt vmcnt(2)
buffer_load_dwordx4 v[76:79], v2, s[24:27], s32 offen offset:0 nt
s_mov_b64 exec, 1
v_mov_b32 v6, 2
ds_add_u32 v0, v6 offset:1352
s_mov_b64 exec, -1
s_waitcnt vmcnt(2)
buffer_load_dwordx4 v[80:83], v2, s[24:27], s32 offen offset:128 nt
v_mov_b32 v6, 0
ds_read_b32 v6, v6 offset:1356
s_waitcnt lgkmcnt(0)
v_cmp_eq_u32 vcc, 1, v6
s_waitcnt vmcnt(2)
buffer_load_dwordx4 v[84:87], v2, s[24:27], s32 offen offset:256 nt
s_mov_b64 exec, 1
v_mov_b32 v6, 2
ds_add_u32 v0, v6 offset:1352
s_mov_b64 exec, -1
v_mfma_f32_32x32x16_bf16 v[40:55], v[60:63], v[24:27], 0
v_mfma_f32_32x32x16_bf16 v[40:55], v[64:67], v[28:31], v[40:55]
v_mfma_f32_32x32x16_bf16 v[40:55], v[68:71], v[32:35], v[40:55]
v_mfma_f32_32x32x16_bf16 v[40:55], v[72:75], v[36:39], v[40:55]
s_waitcnt vmcnt(2)
s_cbranch_vccnz L_w55
s_waitcnt vmcnt(1)
L_w55:
buffer_load_dwordx4 v[60:63], v2, s[24:27], s32 offen offset:384 nt
s_nop 11
v_add_f32_dpp v56, v41, v40 quad_perm:[1,1,1,1] row_mask:0xf bank_mask:0xf
v_add_f32_dpp v57, v45, v44 quad_perm:[1,1,1,1] row_mask:0xf bank_mask:0xf
v_add_f32_dpp v58, v49, v48 quad_perm:[1,1,1,1] row_mask:0xf bank_mask:0xf
v_add_f32_dpp v59, v53, v52 quad_perm:[1,1,1,1] row_mask:0xf bank_mask:0xf
v_add_f32_dpp v56, v42, v56 quad_perm:[2,2,2,2] row_mask:0xf bank_mask:0xf
v_add_f32_dpp v57, v46, v57 quad_perm:[2,2,2,2] row_mask:0xf bank_mask:0xf
v_add_f32_dpp v58, v50, v58 quad_perm:[2,2,2,2] row_mask:0xf bank_mask:0xf
v_add_f32_dpp v59, v54, v59 quad_perm:[2,2,2,2] row_mask:0xf bank_mask:0xf
v_add_f32_dpp v56, v43, v56 quad_perm:[3,3,3,3] row_mask:0xf bank_mask:0xf
v_add_f32_dpp v57, v47, v57 quad_perm:[3,3,3,3] row_mask:0xf bank_mask:0xf
v_add_f32_dpp v58, v51, v58 quad_perm:[3,3,3,3] row_mask:0xf bank_mask:0xf
v_add_f32_dpp v59, v55, v59 quad_perm:[3,3,3,3] row_mask:0xf bank_mask:0xf
s_nop 1
v_permlane32_swap_b32 v56, v57
v_permlane32_swap_b32 v58, v59
s_nop 0
v_add_f32_dpp v56, v57, v56 row_shl:4 row_mask:0xf bank_mask:0xf bound_ctrl:0
v_add_f32_dpp v58, v59, v58 row_shl:4 row_mask:0xf bank_mask:0xf bound_ctrl:0
v_max3_f32 v4, v56, v58, v4
v_cvt_pk_bf16_f32 v20, v56, v58
s_xor_b32 s32, s33, 1835008
s_waitcnt vmcnt(2)
buffer_load_dwordx4 v[64:67], v2, s[24:27], s32 offen offset:0 nt
s_mov_b64 exec, 1
v_mov_b32 v6, 2
ds_add_u32 v0, v6 offset:1352
s_mov_b64 exec, -1
s_waitcnt vmcnt(2)
buffer_load_dwordx4 v[68:71], v2, s[24:27], s32 offen offset:128 nt
v_mov_b32 v6, 0
ds_read_b32 v6, v6 offset:1356
s_waitcnt lgkmcnt(0)
v_cmp_eq_u32 vcc, 1, v6
s_waitcnt vmcnt(2)
buffer_load_dwordx4 v[72:75], v2, s[24:27], s32 offen offset:256 nt
s_mov_b64 exec, 1
v_mov_b32 v6, 2
ds_add_u32 v0, v6 offset:1352
s_mov_b64 exec, -1
v_mfma_f32_32x32x16_bf16 v[40:55], v[76:79], v[24:27], 0
v_mfma_f32_32x32x16_bf16 v[40:55], v[80:83], v[28:31], v[40:55]
v_mfma_f32_32x32x16_bf16 v[40:55], v[84:87], v[32:35], v[40:55]
v_mfma_f32_32x32x16_bf16 v[40:55], v[60:63], v[36:39], v[40:55]
s_waitcnt vmcnt(2)
s_cbranch_vccnz L_w59
s_waitcnt vmcnt(1)
L_w59:
buffer_load_dwordx4 v[60:63], v2, s[24:27], s32 offen offset:384 nt
s_nop 11
v_add_f32_dpp v56, v41, v40 quad_perm:[1,1,1,1] row_mask:0xf bank_mask:0xf
v_add_f32_dpp v57, v45, v44 quad_perm:[1,1,1,1] row_mask:0xf bank_mask:0xf
v_add_f32_dpp v58, v49, v48 quad_perm:[1,1,1,1] row_mask:0xf bank_mask:0xf
v_add_f32_dpp v59, v53, v52 quad_perm:[1,1,1,1] row_mask:0xf bank_mask:0xf
v_add_f32_dpp v56, v42, v56 quad_perm:[2,2,2,2] row_mask:0xf bank_mask:0xf
v_add_f32_dpp v57, v46, v57 quad_perm:[2,2,2,2] row_mask:0xf bank_mask:0xf
v_add_f32_dpp v58, v50, v58 quad_perm:[2,2,2,2] row_mask:0xf bank_mask:0xf
v_add_f32_dpp v59, v54, v59 quad_perm:[2,2,2,2] row_mask:0xf bank_mask:0xf
v_add_f32_dpp v56, v43, v56 quad_perm:[3,3,3,3] row_mask:0xf bank_mask:0xf
v_add_f32_dpp v57, v47, v57 quad_perm:[3,3,3,3] row_mask:0xf bank_mask:0xf
v_add_f32_dpp v58, v51, v58 quad_perm:[3,3,3,3] row_mask:0xf bank_mask:0xf
v_add_f32_dpp v59, v55, v59 quad_perm:[3,3,3,3] row_mask:0xf bank_mask:0xf
s_nop 1
v_permlane32_swap_b32 v56, v57
v_permlane32_swap_b32 v58, v59
s_nop 0
v_add_f32_dpp v56, v57, v56 row_shl:4 row_mask:0xf bank_mask:0xf bound_ctrl:0
v_add_f32_dpp v58, v59, v58 row_shl:4 row_mask:0xf bank_mask:0xf bound_ctrl:0
v_max3_f32 v4, v56, v58, v4
v_cvt_pk_bf16_f32 v21, v56, v58
s_xor_b32 s32, s33, 1966080
s_waitcnt vmcnt(2)
buffer_load_dwordx4 v[76:79], v2, s[24:27], s32 offen offset:0 nt
s_mov_b64 exec, 1
v_mov_b32 v6, 2
ds_add_u32 v0, v6 offset:1352
s_mov_b64 exec, -1
s_waitcnt vmcnt(2)
buffer_load_dwordx4 v[80:83], v2, s[24:27], s32 offen offset:128 nt
v_mov_b32 v6, 0
ds_read_b32 v6, v6 offset:1356
s_waitcnt lgkmcnt(0)
v_cmp_eq_u32 vcc, 1, v6
s_waitcnt vmcnt(2)
buffer_load_dwordx4 v[84:87], v2, s[24:27], s32 offen offset:256 nt
s_mov_b64 exec, 1
v_mov_b32 v6, 2
ds_add_u32 v0, v6 offset:1352
s_mov_b64 exec, -1
v_mfma_f32_32x32x16_bf16 v[40:55], v[64:67], v[24:27], 0
v_mfma_f32_32x32x16_bf16 v[40:55], v[68:71], v[28:31], v[40:55]
v_mfma_f32_32x32x16_bf16 v[40:55], v[72:75], v[32:35], v[40:55]
v_mfma_f32_32x32x16_bf16 v[40:55], v[60:63], v[36:39], v[40:55]
s_waitcnt vmcnt(2)
s_cbranch_vccnz L_w63
s_waitcnt vmcnt(1)
L_w63:
buffer_load_dwordx4 v[60:63], v2, s[24:27], s32 offen offset:384 nt
s_nop 11
v_add_f32_dpp v56, v41, v40 quad_perm:[1,1,1,1] row_mask:0xf bank_mask:0xf
v_add_f32_dpp v57, v45, v44 quad_perm:[1,1,1,1] row_mask:0xf bank_mask:0xf
v_add_f32_dpp v58, v49, v48 quad_perm:[1,1,1,1] row_mask:0xf bank_mask:0xf
v_add_f32_dpp v59, v53, v52 quad_perm:[1,1,1,1] row_mask:0xf bank_mask:0xf
v_add_f32_dpp v56, v42, v56 quad_perm:[2,2,2,2] row_mask:0xf bank_mask:0xf
v_add_f32_dpp v57, v46, v57 quad_perm:[2,2,2,2] row_mask:0xf bank_mask:0xf
v_add_f32_dpp v58, v50, v58 quad_perm:[2,2,2,2] row_mask:0xf bank_mask:0xf
v_add_f32_dpp v59, v54, v59 quad_perm:[2,2,2,2] row_mask:0xf bank_mask:0xf
v_add_f32_dpp v56, v43, v56 quad_perm:[3,3,3,3] row_mask:0xf bank_mask:0xf
v_add_f32_dpp v57, v47, v57 quad_perm:[3,3,3,3] row_mask:0xf bank_mask:0xf
v_add_f32_dpp v58, v51, v58 quad_perm:[3,3,3,3] row_mask:0xf bank_mask:0xf
v_add_f32_dpp v59, v55, v59 quad_perm:[3,3,3,3] row_mask:0xf bank_mask:0xf
s_nop 1
v_permlane32_swap_b32 v56, v57
v_permlane32_swap_b32 v58, v59
s_nop 0
v_add_f32_dpp v56, v57, v56 row_shl:4 row_mask:0xf bank_mask:0xf bound_ctrl:0
v_add_f32_dpp v58, v59, v58 row_shl:4 row_mask:0xf bank_mask:0xf bound_ctrl:0
v_max3_f32 v4, v56, v58, v4
v_cvt_pk_bf16_f32 v22, v56, v58
s_waitcnt vmcnt(2)
buffer_load_dwordx4 v[104:107], v3, s[28:31], s44 offen offset:0 nt
s_mov_b64 exec, 1
v_mov_b32 v6, 2
ds_add_u32 v0, v6 offset:1352
s_mov_b64 exec, -1
s_xor_b32 s32, s44, 8192
s_waitcnt vmcnt(2)
buffer_load_dwordx4 v[108:111], v3, s[28:31], s32 offen offset:0 nt
v_mov_b32 v6, 0
ds_read_b32 v6, v6 offset:1356
s_waitcnt lgkmcnt(0)
v_cmp_eq_u32 vcc, 1, v6
s_waitcnt vmcnt(2)
s_cbranch_vccnz L_w66
s_waitcnt vmcnt(1)
L_w66:
buffer_load_dwordx4 v[112:115], v3, s[28:31], s44 offen offset:256 nt
s_mov_b64 exec, 1
v_mov_b32 v6, 2
ds_add_u32 v0, v6 offset:1352
s_mov_b64 exec, -1
v_mfma_f32_32x32x16_bf16 v[40:55], v[76:79], v[24:27], 0
v_mfma_f32_32x32x16_bf16 v[40:55], v[80:83], v[28:31], v[40:55]
v_mfma_f32_32x32x16_bf16 v[40:55], v[84:87], v[32:35], v[40:55]
v_mfma_f32_32x32x16_bf16 v[40:55], v[60:63], v[36:39], v[40:55]
s_waitcnt vmcnt(2)
buffer_load_dwordx4 v[116:119], v3, s[28:31], s32 offen offset:256 nt
s_nop 11
v_add_f32_dpp v56, v41, v40 quad_perm:[1,1,1,1] row_mask:0xf bank_mask:0xf
v_add_f32_dpp v57, v45, v44 quad_perm:[1,1,1,1] row_mask:0xf bank_mask:0xf
v_add_f32_dpp v58, v49, v48 quad_perm:[1,1,1,1] row_mask:0xf bank_mask:0xf
v_add_f32_dpp v59, v53, v52 quad_perm:[1,1,1,1] row_mask:0xf bank_mask:0xf
v_add_f32_dpp v56, v42, v56 quad_perm:[2,2,2,2] row_mask:0xf bank_mask:0xf
v_add_f32_dpp v57, v46, v57 quad_perm:[2,2,2,2] row_mask:0xf bank_mask:0xf
v_add_f32_dpp v58, v50, v58 quad_perm:[2,2,2,2] row_mask:0xf bank_mask:0xf
v_add_f32_dpp v59, v54, v59 quad_perm:[2,2,2,2] row_mask:0xf bank_mask:0xf
v_add_f32_dpp v56, v43, v56 quad_perm:[3,3,3,3] row_mask:0xf bank_mask:0xf
v_add_f32_dpp v57, v47, v57 quad_perm:[3,3,3,3] row_mask:0xf bank_mask:0xf
v_add_f32_dpp v58, v51, v58 quad_perm:[3,3,3,3] row_mask:0xf bank_mask:0xf
v_add_f32_dpp v59, v55, v59 quad_perm:[3,3,3,3] row_mask:0xf bank_mask:0xf
s_nop 1
v_permlane32_swap_b32 v56, v57
v_permlane32_swap_b32 v58, v59
s_nop 0
v_add_f32_dpp v56, v57, v56 row_shl:4 row_mask:0xf bank_mask:0xf bound_ctrl:0
v_add_f32_dpp v58, v59, v58 row_shl:4 row_mask:0xf bank_mask:0xf bound_ctrl:0
v_max3_f32 v4, v56, v58, v4
v_cvt_pk_bf16_f32 v23, v56, v58
s_xor_b32 s32, s44, 131072
s_waitcnt vmcnt(2)
buffer_load_dwordx4 v[120:123], v3, s[28:31], s32 offen offset:0 nt
s_mov_b64 exec, 1
v_mov_b32 v6, 2
ds_add_u32 v0, v6 offset:1352
s_mov_b64 exec, -1
v_mov_b32 v5, v4
s_nop 1
v_permlane16_swap_b32 v4, v5
v_max_f32 v4, v4, v5
v_mov_b32 v5, v4
s_nop 1
v_permlane32_swap_b32 v4, v5
v_max_f32 v4, v4, v5
v_cvt_pk_bf16_f32 v4, v4, v4
v_and_b32 v4, 0xffff0000, v4
s_mov_b32 s9, 1035512379
v_mul_f32 v4, s9, v4
v_mov_b32 v5, 0
s_xor_b32 s32, s44, 139264
s_waitcnt vmcnt(2)
buffer_load_dwordx4 v[124:127], v3, s[28:31], s32 offen offset:0 nt
v_mov_b32 v6, 0
ds_read_b32 v6, v6 offset:1356
s_waitcnt lgkmcnt(0)
v_cmp_eq_u32 vcc, 1, v6
v_lshlrev_b32 v88, 16, v8
v_and_b32 v89, 0xffff0000, v8
v_fma_f32 v88, v88, s9, -v4
v_fma_f32 v89, v89, s9, -v4
v_exp_f32 v88, v88
v_exp_f32 v89, v89
v_add_f32 v5, v5, v88
v_add_f32 v5, v5, v89
v_cvt_pk_bf16_f32 v8, v88, v89
v_lshlrev_b32 v90, 16, v9
v_and_b32 v91, 0xffff0000, v9
v_fma_f32 v90, v90, s9, -v4
v_fma_f32 v91, v91, s9, -v4
v_exp_f32 v90, v90
v_exp_f32 v91, v91
v_add_f32 v5, v5, v90
v_add_f32 v5, v5, v91
v_cvt_pk_bf16_f32 v9, v90, v91
v_lshlrev_b32 v92, 16, v10
v_and_b32 v93, 0xffff0000, v10
v_fma_f32 v92, v92, s9, -v4
v_fma_f32 v93, v93, s9, -v4
v_exp_f32 v92, v92
v_exp_f32 v93, v93
v_add_f32 v5, v5, v92
v_add_f32 v5, v5, v93
v_cvt_pk_bf16_f32 v10, v92, v93
v_lshlrev_b32 v94, 16, v11
v_and_b32 v95, 0xffff0000, v11
v_fma_f32 v94, v94, s9, -v4
v_fma_f32 v95, v95, s9, -v4
v_exp_f32 v94, v94
v_exp_f32 v95, v95
v_add_f32 v5, v5, v94
v_add_f32 v5, v5, v95
v_cvt_pk_bf16_f32 v11, v94, v95
s_xor_b32 s32, s44, 131072
s_waitcnt vmcnt(2)
s_cbranch_vccnz L_w70
s_waitcnt vmcnt(1)
L_w70:
buffer_load_dwordx4 v[128:131], v3, s[28:31], s32 offen offset:256 nt
s_mov_b64 exec, 1
v_mov_b32 v6, 2
ds_add_u32 v0, v6 offset:1352
s_mov_b64 exec, -1
v_lshlrev_b32 v88, 16, v12
v_and_b32 v89, 0xffff0000, v12
v_fma_f32 v88, v88, s9, -v4
v_fma_f32 v89, v89, s9, -v4
v_exp_f32 v88, v88
v_exp_f32 v89, v89
v_add_f32 v5, v5, v88
v_add_f32 v5, v5, v89
v_cvt_pk_bf16_f32 v12, v88, v89
v_lshlrev_b32 v90, 16, v13
v_and_b32 v91, 0xffff0000, v13
v_fma_f32 v90, v90, s9, -v4
v_fma_f32 v91, v91, s9, -v4
v_exp_f32 v90, v90
v_exp_f32 v91, v91
v_add_f32 v5, v5, v90
v_add_f32 v5, v5, v91
v_cvt_pk_bf16_f32 v13, v90, v91
v_lshlrev_b32 v92, 16, v14
v_and_b32 v93, 0xffff0000, v14
v_fma_f32 v92, v92, s9, -v4
v_fma_f32 v93, v93, s9, -v4
v_exp_f32 v92, v92
v_exp_f32 v93, v93
v_add_f32 v5, v5, v92
v_add_f32 v5, v5, v93
v_cvt_pk_bf16_f32 v14, v92, v93
v_lshlrev_b32 v94, 16, v15
v_and_b32 v95, 0xffff0000, v15
v_fma_f32 v94, v94, s9, -v4
v_fma_f32 v95, v95, s9, -v4
v_exp_f32 v94, v94
v_exp_f32 v95, v95
v_add_f32 v5, v5, v94
v_add_f32 v5, v5, v95
v_cvt_pk_bf16_f32 v15, v94, v95
s_xor_b32 s32, s44, 139264
s_waitcnt vmcnt(2)
buffer_load_dwordx4 v[132:135], v3, s[28:31], s32 offen offset:256 nt
v_lshlrev_b32 v88, 16, v16
v_and_b32 v89, 0xffff0000, v16
v_fma_f32 v88, v88, s9, -v4
v_fma_f32 v89, v89, s9, -v4
v_exp_f32 v88, v88
v_exp_f32 v89, v89
v_add_f32 v5, v5, v88
v_add_f32 v5, v5, v89
v_cvt_pk_bf16_f32 v16, v88, v89
v_lshlrev_b32 v90, 16, v17
v_and_b32 v91, 0xffff0000, v17
v_fma_f32 v90, v90, s9, -v4
v_fma_f32 v91, v91, s9, -v4
v_exp_f32 v90, v90
v_exp_f32 v91, v91
v_add_f32 v5, v5, v90
v_add_f32 v5, v5, v91
v_cvt_pk_bf16_f32 v17, v90, v91
v_lshlrev_b32 v92, 16, v18
v_and_b32 v93, 0xffff0000, v18
v_fma_f32 v92, v92, s9, -v4
v_fma_f32 v93, v93, s9, -v4
v_exp_f32 v92, v92
v_exp_f32 v93, v93
v_add_f32 v5, v5, v92
v_add_f32 v5, v5, v93
v_cvt_pk_bf16_f32 v18, v92, v93
v_lshlrev_b32 v94, 16, v19
v_and_b32 v95, 0xffff0000, v19
v_fma_f32 v94, v94, s9, -v4
v_fma_f32 v95, v95, s9, -v4
v_exp_f32 v94, v94
v_exp_f32 v95, v95
v_add_f32 v5, v5, v94
v_add_f32 v5, v5, v95
v_cvt_pk_bf16_f32 v19, v94, v95
s_xor_b32 s32, s44, 262144
s_waitcnt vmcnt(2)
buffer_load_dwordx4 v[136:139], v3, s[28:31], s32 offen offset:0 nt
s_mov_b64 exec, 1
v_mov_b32 v6, 2
ds_add_u32 v0, v6 offset:1352
s_mov_b64 exec, -1
v_lshlrev_b32 v88, 16, v20
v_and_b32 v89, 0xffff0000, v20
v_fma_f32 v88, v88, s9, -v4
v_fma_f32 v89, v89, s9, -v4
v_exp_f32 v88, v88
v_exp_f32 v89, v89
v_add_f32 v5, v5, v88
v_add_f32 v5, v5, v89
v_cvt_pk_bf16_f32 v20, v88, v89
v_lshlrev_b32 v90, 16, v21
v_and_b32 v91, 0xffff0000, v21
v_fma_f32 v90, v90, s9, -v4
v_fma_f32 v91, v91, s9, -v4
v_exp_f32 v90, v90
v_exp_f32 v91, v91
v_add_f32 v5, v5, v90
v_add_f32 v5, v5, v91
v_cvt_pk_bf16_f32 v21, v90, v91
v_lshlrev_b32 v92, 16, v22
v_and_b32 v93, 0xffff0000, v22
v_fma_f32 v92, v92, s9, -v4
v_fma_f32 v93, v93, s9, -v4
v_exp_f32 v92, v92
v_exp_f32 v93, v93
v_add_f32 v5, v5, v92
v_add_f32 v5, v5, v93
v_cvt_pk_bf16_f32 v22, v92, v93
v_lshlrev_b32 v94, 16, v23
v_and_b32 v95, 0xffff0000, v23
v_fma_f32 v94, v94, s9, -v4
v_fma_f32 v95, v95, s9, -v4
v_exp_f32 v94, v94
v_exp_f32 v95, v95
v_add_f32 v5, v5, v94
v_add_f32 v5, v5, v95
v_cvt_pk_bf16_f32 v23, v94, v95
s_xor_b32 s32, s44, 270336
s_waitcnt vmcnt(2)
buffer_load_dwordx4 v[140:143], v3, s[28:31], s32 offen offset:0 nt
v_mov_b32 v6, 0
ds_read_b32 v6, v6 offset:1356
s_waitcnt lgkmcnt(0)
v_cmp_eq_u32 vcc, 1, v6
v_mov_b32 v6, v5
s_nop 1
v_permlane16_swap_b32 v5, v6
v_add_f32 v5, v5, v6
v_mov_b32 v6, v5
s_nop 1
v_permlane32_swap_b32 v5, v6
v_add_f32 v5, v5, v6
s_lshl_b32 s9, s3, 2
v_lshl_add_u32 v6, v0, 2, s9
s_mov_b64 exec, 0x101
ds_write_b32 v6, v4 offset:1152
ds_write_b32 v6, v5 offset:1216
s_mov_b64 exec, 1
v_mov_b32 v6, 1
v_mov_b32 v5, 0
ds_add_u32 v5, v6 offset:1344
s_mov_b64 exec, -1
s_xor_b32 s32, s44, 262144
s_waitcnt vmcnt(2)
s_cbranch_vccnz L_w74
s_waitcnt vmcnt(1)
L_w74:
buffer_load_dwordx4 v[144:147], v3, s[28:31], s32 offen offset:256 nt
s_mov_b64 exec, 1
v_mov_b32 v6, 2
ds_add_u32 v0, v6 offset:1352
s_mov_b64 exec, -1
v_perm_b32 v88, v108, v104, s6
v_perm_b32 v89, v124, v120, s6
v_perm_b32 v90, v108, v104, s7
v_perm_b32 v91, v124, v120, s7
v_perm_b32 v92, v109, v105, s6
v_perm_b32 v93, v125, v121, s6
v_perm_b32 v94, v109, v105, s7
v_perm_b32 v95, v125, v121, s7
v_mfma_f32_16x16x16_bf16 v[24:27], v[8:9], v[88:89], 0
v_mfma_f32_16x16x16_bf16 v[28:31], v[8:9], v[90:91], 0
v_mfma_f32_16x16x16_bf16 v[32:35], v[8:9], v[92:93], 0
v_mfma_f32_16x16x16_bf16 v[36:39], v[8:9], v[94:95], 0
s_xor_b32 s32, s44, 270336
s_waitcnt vmcnt(2)
buffer_load_dwordx4 v[148:151], v3, s[28:31], s32 offen offset:256 nt
v_perm_b32 v96, v110, v106, s6
v_perm_b32 v97, v126, v122, s6
v_perm_b32 v98, v110, v106, s7
v_perm_b32 v99, v126, v122, s7
v_perm_b32 v100, v111, v107, s6
v_perm_b32 v101, v127, v123, s6
v_perm_b32 v102, v111, v107, s7
v_perm_b32 v103, v127, v123, s7
v_mfma_f32_16x16x16_bf16 v[40:43], v[8:9], v[96:97], 0
v_mfma_f32_16x16x16_bf16 v[44:47], v[8:9], v[98:99], 0
v_mfma_f32_16x16x16_bf16 v[48:51], v[8:9], v[100:101], 0
v_mfma_f32_16x16x16_bf16 v[52:55], v[8:9], v[102:103], 0
s_xor_b32 s32, s44, 393216
s_waitcnt vmcnt(2)
buffer_load_dwordx4 v[152:155], v3, s[28:31], s32 offen offset:0 nt
s_mov_b64 exec, 1
v_mov_b32 v6, 2
ds_add_u32 v0, v6 offset:1352
s_mov_b64 exec, -1
v_perm_b32 v88, v116, v112, s6
v_perm_b32 v89, v132, v128, s6
v_perm_b32 v90, v116, v112, s7
v_perm_b32 v91, v132, v128, s7
v_perm_b32 v92, v117, v113, s6
v_perm_b32 v93, v133, v129, s6
v_perm_b32 v94, v117, v113, s7
v_perm_b32 v95, v133, v129, s7
v_mfma_f32_16x16x16_bf16 v[56:59], v[8:9], v[88:89], 0
v_mfma_f32_16x16x16_bf16 v[60:63], v[8:9], v[90:91], 0
v_mfma_f32_16x16x16_bf16 v[64:67], v[8:9], v[92:93], 0
v_mfma_f32_16x16x16_bf16 v[68:71], v[8:9], v[94:95], 0
s_xor_b32 s32, s44, 401408
s_waitcnt vmcnt(2)
buffer_load_dwordx4 v[156:159], v3, s[28:31], s32 offen offset:0 nt
v_mov_b32 v6, 0
ds_read_b32 v6, v6 offset:1356
s_waitcnt lgkmcnt(0)
v_cmp_eq_u32 vcc, 1, v6
v_perm_b32 v96, v118, v114, s6
v_perm_b32 v97, v134, v130, s6
v_perm_b32 v98, v118, v114, s7
v_perm_b32 v99, v134, v130, s7
v_perm_b32 v100, v119, v115, s6
v_perm_b32 v101, v135, v131, s6
v_perm_b32 v102, v119, v115, s7
v_perm_b32 v103, v135, v131, s7
v_mfma_f32_16x16x16_bf16 v[72:75], v[8:9], v[96:97], 0
v_mfma_f32_16x16x16_bf16 v[76:79], v[8:9], v[98:99], 0
v_mfma_f32_16x16x16_bf16 v[80:83], v[8:9], v[100:101], 0
v_mfma_f32_16x16x16_bf16 v[84:87], v[8:9], v[102:103], 0
s_xor_b32 s32, s44, 393216
s_waitcnt vmcnt(2)
s_cbranch_vccnz L_w78
s_waitcnt vmcnt(1)
L_w78:
buffer_load_dwordx4 v[160:163], v3, s[28:31], s32 offen offset:256 nt
s_mov_b64 exec, 1
v_mov_b32 v4, 2
ds_add_u32 v0, v4 offset:1352
s_mov_b64 exec, -1
s_xor_b32 s32, s44, 401408
s_waitcnt vmcnt(2)
buffer_load_dwordx4 v[164:167], v3, s[28:31], s32 offen offset:256 nt
s_xor_b32 s32, s44, 524288
s_waitcnt vmcnt(2)
buffer_load_dwordx4 v[104:107], v3, s[28:31], s32 offen offset:0 nt
s_mov_b64 exec, 1
v_mov_b32 v4, 2
ds_add_u32 v0, v4 offset:1352
s_mov_b64 exec, -1
v_perm_b32 v88, v140, v136, s6
v_perm_b32 v89, v156, v152, s6
v_perm_b32 v90, v140, v136, s7
v_perm_b32 v91, v156, v152, s7
v_perm_b32 v92, v141, v137, s6
v_perm_b32 v93, v157, v153, s6
v_perm_b32 v94, v141, v137, s7
v_perm_b32 v95, v157, v153, s7
v_mfma_f32_16x16x16_bf16 v[24:27], v[10:11], v[88:89], v[24:27]
v_mfma_f32_16x16x16_bf16 v[28:31], v[10:11], v[90:91], v[28:31]
v_mfma_f32_16x16x16_bf16 v[32:35], v[10:11], v[92:93], v[32:35]
v_mfma_f32_16x16x16_bf16 v[36:39], v[10:11], v[94:95], v[36:39]
s_xor_b32 s32, s44, 532480
s_waitcnt vmcnt(2)
buffer_load_dwordx4 v[108:111], v3, s[28:31], s32 offen offset:0 nt
v_mov_b32 v4, 0
ds_read_b32 v4, v4 offset:1356
s_waitcnt lgkmcnt(0)
v_cmp_eq_u32 vcc, 1, v4
v_perm_b32 v96, v142, v138, s6
v_perm_b32 v97, v158, v154, s6
v_perm_b32 v98, v142, v138, s7
v_perm_b32 v99, v158, v154, s7
v_perm_b32 v100, v143, v139, s6
v_perm_b32 v101, v159, v155, s6
v_perm_b32 v102, v143, v139, s7
v_perm_b32 v103, v159, v155, s7
v_mfma_f32_16x16x16_bf16 v[40:43], v[10:11], v[96:97], v[40:43]
v_mfma_f32_16x16x16_bf16 v[44:47], v[10:11], v[98:99], v[44:47]
v_mfma_f32_16x16x16_bf16 v[48:51], v[10:11], v[100:101], v[48:51]
v_mfma_f32_16x16x16_bf16 v[52:55], v[10:11], v[102:103], v[52:55]
s_xor_b32 s32, s44, 524288
s_waitcnt vmcnt(2)
s_cbranch_vccnz L_w82
s_waitcnt vmcnt(1)
L_w82:
buffer_load_dwordx4 v[112:115], v3, s[28:31], s32 offen offset:256 nt
s_mov_b64 exec, 1
v_mov_b32 v4, 2
ds_add_u32 v0, v4 offset:1352
s_mov_b64 exec, -1
v_perm_b32 v88, v148, v144, s6
v_perm_b32 v89, v164, v160, s6
v_perm_b32 v90, v148, v144, s7
v_perm_b32 v91, v164, v160, s7
v_perm_b32 v92, v149, v145, s6
v_perm_b32 v93, v165, v161, s6
v_perm_b32 v94, v149, v145, s7
v_perm_b32 v95, v165, v161, s7
v_mfma_f32_16x16x16_bf16 v[56:59], v[10:11], v[88:89], v[56:59]
v_mfma_f32_16x16x16_bf16 v[60:63], v[10:11], v[90:91], v[60:63]
v_mfma_f32_16x16x16_bf16 v[64:67], v[10:11], v[92:93], v[64:67]
v_mfma_f32_16x16x16_bf16 v[68:71], v[10:11], v[94:95], v[68:71]
s_xor_b32 s32, s44, 532480
s_waitcnt vmcnt(2)
buffer_load_dwordx4 v[116:119], v3, s[28:31], s32 offen offset:256 nt
v_perm_b32 v96, v150, v146, s6
v_perm_b32 v97, v166, v162, s6
v_perm_b32 v98, v150, v146, s7
v_perm_b32 v99, v166, v162, s7
v_perm_b32 v100, v151, v147, s6
v_perm_b32 v101, v167, v163, s6
v_perm_b32 v102, v151, v147, s7
v_perm_b32 v103, v167, v163, s7
v_mfma_f32_16x16x16_bf16 v[72:75], v[10:11], v[96:97], v[72:75]
v_mfma_f32_16x16x16_bf16 v[76:79], v[10:11], v[98:99], v[76:79]
v_mfma_f32_16x16x16_bf16 v[80:83], v[10:11], v[100:101], v[80:83]
v_mfma_f32_16x16x16_bf16 v[84:87], v[10:11], v[102:103], v[84:87]
s_xor_b32 s32, s44, 655360
s_waitcnt vmcnt(2)
buffer_load_dwordx4 v[120:123], v3, s[28:31], s32 offen offset:0 nt
s_mov_b64 exec, 1
v_mov_b32 v4, 2
ds_add_u32 v0, v4 offset:1352
s_mov_b64 exec, -1
s_xor_b32 s32, s44, 663552
s_waitcnt vmcnt(2)
buffer_load_dwordx4 v[124:127], v3, s[28:31], s32 offen offset:0 nt
v_mov_b32 v4, 0
ds_read_b32 v4, v4 offset:1356
s_waitcnt lgkmcnt(0)
v_cmp_eq_u32 vcc, 1, v4
s_xor_b32 s32, s44, 655360
s_waitcnt vmcnt(2)
s_cbranch_vccnz L_w86
s_waitcnt vmcnt(1)
L_w86:
buffer_load_dwordx4 v[128:131], v3, s[28:31], s32 offen offset:256 nt
s_mov_b64 exec, 1
v_mov_b32 v4, 2
ds_add_u32 v0, v4 offset:1352
s_mov_b64 exec, -1
s_xor_b32 s32, s44, 663552
s_waitcnt vmcnt(2)
buffer_load_dwordx4 v[132:135], v3, s[28:31], s32 offen offset:256 nt
s_xor_b32 s32, s44, 786432
s_waitcnt vmcnt(2)
buffer_load_dwordx4 v[136:139], v3, s[28:31], s32 offen offset:0 nt
s_mov_b64 exec, 1
v_mov_b32 v4, 2
ds_add_u32 v0, v4 offset:1352
s_mov_b64 exec, -1
v_perm_b32 v88, v108, v104, s6
v_perm_b32 v89, v124, v120, s6
v_perm_b32 v90, v108, v104, s7
v_perm_b32 v91, v124, v120, s7
v_perm_b32 v92, v109, v105, s6
v_perm_b32 v93, v125, v121, s6
v_perm_b32 v94, v109, v105, s7
v_perm_b32 v95, v125, v121, s7
v_mfma_f32_16x16x16_bf16 v[24:27], v[12:13], v[88:89], v[24:27]
v_mfma_f32_16x16x16_bf16 v[28:31], v[12:13], v[90:91], v[28:31]
v_mfma_f32_16x16x16_bf16 v[32:35], v[12:13], v[92:93], v[32:35]
v_mfma_f32_16x16x16_bf16 v[36:39], v[12:13], v[94:95], v[36:39]
s_xor_b32 s32, s44, 794624
s_waitcnt vmcnt(2)
buffer_load_dwordx4 v[140:143], v3, s[28:31], s32 offen offset:0 nt
v_mov_b32 v4, 0
ds_read_b32 v4, v4 offset:1356
s_waitcnt lgkmcnt(0)
v_cmp_eq_u32 vcc, 1, v4
v_perm_b32 v96, v110, v106, s6
v_perm_b32 v97, v126, v122, s6
v_perm_b32 v98, v110, v106, s7
v_perm_b32 v99, v126, v122, s7
v_perm_b32 v100, v111, v107, s6
v_perm_b32 v101, v127, v123, s6
v_perm_b32 v102, v111, v107, s7
v_perm_b32 v103, v127, v123, s7
v_mfma_f32_16x16x16_bf16 v[40:43], v[12:13], v[96:97], v[40:43]
v_mfma_f32_16x16x16_bf16 v[44:47], v[12:13], v[98:99], v[44:47]
v_mfma_f32_16x16x16_bf16 v[48:51], v[12:13], v[100:101], v[48:51]
v_mfma_f32_16x16x16_bf16 v[52:55], v[12:13], v[102:103], v[52:55]
s_xor_b32 s32, s44, 786432
s_waitcnt vmcnt(2)
s_cbranch_vccnz L_w90
s_waitcnt vmcnt(1)
L_w90:
buffer_load_dwordx4 v[144:147], v3, s[28:31], s32 offen offset:256 nt
s_mov_b64 exec, 1
v_mov_b32 v4, 2
ds_add_u32 v0, v4 offset:1352
s_mov_b64 exec, -1
v_perm_b32 v88, v116, v112, s6
v_perm_b32 v89, v132, v128, s6
v_perm_b32 v90, v116, v112, s7
v_perm_b32 v91, v132, v128, s7
v_perm_b32 v92, v117, v113, s6
v_perm_b32 v93, v133, v129, s6
v_perm_b32 v94, v117, v113, s7
v_perm_b32 v95, v133, v129, s7
v_mfma_f32_16x16x16_bf16 v[56:59], v[12:13], v[88:89], v[56:59]
v_mfma_f32_16x16x16_bf16 v[60:63], v[12:13], v[90:91], v[60:63]
v_mfma_f32_16x16x16_bf16 v[64:67], v[12:13], v[92:93], v[64:67]
v_mfma_f32_16x16x16_bf16 v[68:71], v[12:13], v[94:95], v[68:71]
s_xor_b32 s32, s44, 794624
s_waitcnt vmcnt(2)
buffer_load_dwordx4 v[148:151], v3, s[28:31], s32 offen offset:256 nt
v_perm_b32 v96, v118, v114, s6
v_perm_b32 v97, v134, v130, s6
v_perm_b32 v98, v118, v114, s7
v_perm_b32 v99, v134, v130, s7
v_perm_b32 v100, v119, v115, s6
v_perm_b32 v101, v135, v131, s6
v_perm_b32 v102, v119, v115, s7
v_perm_b32 v103, v135, v131, s7
v_mfma_f32_16x16x16_bf16 v[72:75], v[12:13], v[96:97], v[72:75]
v_mfma_f32_16x16x16_bf16 v[76:79], v[12:13], v[98:99], v[76:79]
v_mfma_f32_16x16x16_bf16 v[80:83], v[12:13], v[100:101], v[80:83]
v_mfma_f32_16x16x16_bf16 v[84:87], v[12:13], v[102:103], v[84:87]
s_xor_b32 s32, s44, 917504
s_waitcnt vmcnt(2)
buffer_load_dwordx4 v[152:155], v3, s[28:31], s32 offen offset:0 nt
s_mov_b64 exec, 1
v_mov_b32 v4, 2
ds_add_u32 v0, v4 offset:1352
s_mov_b64 exec, -1
s_xor_b32 s32, s44, 925696
s_waitcnt vmcnt(2)
buffer_load_dwordx4 v[156:159], v3, s[28:31], s32 offen offset:0 nt
v_mov_b32 v4, 0
ds_read_b32 v4, v4 offset:1356
s_waitcnt lgkmcnt(0)
v_cmp_eq_u32 vcc, 1, v4
s_xor_b32 s32, s44, 917504
s_waitcnt vmcnt(2)
s_cbranch_vccnz L_w94
s_waitcnt vmcnt(1)
L_w94:
buffer_load_dwordx4 v[160:163], v3, s[28:31], s32 offen offset:256 nt
s_mov_b64 exec, 1
v_mov_b32 v4, 2
ds_add_u32 v0, v4 offset:1352
s_mov_b64 exec, -1
s_xor_b32 s32, s44, 925696
s_waitcnt vmcnt(2)
buffer_load_dwordx4 v[164:167], v3, s[28:31], s32 offen offset:256 nt
s_xor_b32 s32, s44, 1048576
s_waitcnt vmcnt(2)
buffer_load_dwordx4 v[104:107], v3, s[28:31], s32 offen offset:0 nt
s_mov_b64 exec, 1
v_mov_b32 v4, 2
ds_add_u32 v0, v4 offset:1352
s_mov_b64 exec, -1
s_mov_b64 exec, 1
v_mov_b32 v102, 0
v_mov_b32 v103, 1
ds_max_u32 v102, v103 offset:1348
s_mov_b64 exec, -1
v_perm_b32 v88, v140, v136, s6
v_perm_b32 v89, v156, v152, s6
v_perm_b32 v90, v140, v136, s7
v_perm_b32 v91, v156, v152, s7
v_perm_b32 v92, v141, v137, s6
v_perm_b32 v93, v157, v153, s6
v_perm_b32 v94, v141, v137, s7
v_perm_b32 v95, v157, v153, s7
v_mfma_f32_16x16x16_bf16 v[24:27], v[14:15], v[88:89], v[24:27]
v_mfma_f32_16x16x16_bf16 v[28:31], v[14:15], v[90:91], v[28:31]
v_mfma_f32_16x16x16_bf16 v[32:35], v[14:15], v[92:93], v[32:35]
v_mfma_f32_16x16x16_bf16 v[36:39], v[14:15], v[94:95], v[36:39]
s_xor_b32 s32, s44, 1056768
s_waitcnt vmcnt(2)
buffer_load_dwordx4 v[108:111], v3, s[28:31], s32 offen offset:0 nt
v_mov_b32 v4, 0
ds_read_b32 v4, v4 offset:1356
s_waitcnt lgkmcnt(0)
v_cmp_eq_u32 vcc, 1, v4
v_perm_b32 v96, v142, v138, s6
v_perm_b32 v97, v158, v154, s6
v_perm_b32 v98, v142, v138, s7
v_perm_b32 v99, v158, v154, s7
v_perm_b32 v100, v143, v139, s6
v_perm_b32 v101, v159, v155, s6
v_perm_b32 v102, v143, v139, s7
v_perm_b32 v103, v159, v155, s7
v_mfma_f32_16x16x16_bf16 v[40:43], v[14:15], v[96:97], v[40:43]
v_mfma_f32_16x16x16_bf16 v[44:47], v[14:15], v[98:99], v[44:47]
v_mfma_f32_16x16x16_bf16 v[48:51], v[14:15], v[100:101], v[48:51]
v_mfma_f32_16x16x16_bf16 v[52:55], v[14:15], v[102:103], v[52:55]
s_xor_b32 s32, s44, 1048576
s_waitcnt vmcnt(2)
s_cbranch_vccnz L_w98
s_waitcnt vmcnt(1)
L_w98:
buffer_load_dwordx4 v[112:115], v3, s[28:31], s32 offen offset:256 nt
s_mov_b64 exec, 1
v_mov_b32 v4, 2
ds_add_u32 v0, v4 offset:1352
s_mov_b64 exec, -1
v_perm_b32 v88, v148, v144, s6
v_perm_b32 v89, v164, v160, s6
v_perm_b32 v90, v148, v144, s7
v_perm_b32 v91, v164, v160, s7
v_perm_b32 v92, v149, v145, s6
v_perm_b32 v93, v165, v161, s6
v_perm_b32 v94, v149, v145, s7
v_perm_b32 v95, v165, v161, s7
v_mfma_f32_16x16x16_bf16 v[56:59], v[14:15], v[88:89], v[56:59]
v_mfma_f32_16x16x16_bf16 v[60:63], v[14:15], v[90:91], v[60:63]
v_mfma_f32_16x16x16_bf16 v[64:67], v[14:15], v[92:93], v[64:67]
v_mfma_f32_16x16x16_bf16 v[68:71], v[14:15], v[94:95], v[68:71]
s_xor_b32 s32, s44, 1056768
s_waitcnt vmcnt(2)
buffer_load_dwordx4 v[116:119], v3, s[28:31], s32 offen offset:256 nt
v_perm_b32 v96, v150, v146, s6
v_perm_b32 v97, v166, v162, s6
v_perm_b32 v98, v150, v146, s7
v_perm_b32 v99, v166, v162, s7
v_perm_b32 v100, v151, v147, s6
v_perm_b32 v101, v167, v163, s6
v_perm_b32 v102, v151, v147, s7
v_perm_b32 v103, v167, v163, s7
v_mfma_f32_16x16x16_bf16 v[72:75], v[14:15], v[96:97], v[72:75]
v_mfma_f32_16x16x16_bf16 v[76:79], v[14:15], v[98:99], v[76:79]
v_mfma_f32_16x16x16_bf16 v[80:83], v[14:15], v[100:101], v[80:83]
v_mfma_f32_16x16x16_bf16 v[84:87], v[14:15], v[102:103], v[84:87]
s_xor_b32 s32, s44, 1179648
s_waitcnt vmcnt(2)
buffer_load_dwordx4 v[120:123], v3, s[28:31], s32 offen offset:0 nt
s_mov_b64 exec, 1
v_mov_b32 v4, 2
ds_add_u32 v0, v4 offset:1352
s_mov_b64 exec, -1
s_xor_b32 s32, s44, 1187840
s_waitcnt vmcnt(2)
buffer_load_dwordx4 v[124:127], v3, s[28:31], s32 offen offset:0 nt
v_mov_b32 v4, 0
ds_read_b32 v4, v4 offset:1356
s_waitcnt lgkmcnt(0)
v_cmp_eq_u32 vcc, 1, v4
s_xor_b32 s32, s44, 1179648
s_waitcnt vmcnt(2)
s_cbranch_vccnz L_w102
s_waitcnt vmcnt(1)
L_w102:
buffer_load_dwordx4 v[128:131], v3, s[28:31], s32 offen offset:256 nt
s_mov_b64 exec, 1
v_mov_b32 v4, 2
ds_add_u32 v0, v4 offset:1352
s_mov_b64 exec, -1
s_xor_b32 s32, s44, 1187840
s_waitcnt vmcnt(2)
buffer_load_dwordx4 v[132:135], v3, s[28:31], s32 offen offset:256 nt
s_xor_b32 s32, s44, 1310720
s_waitcnt vmcnt(2)
buffer_load_dwordx4 v[136:139], v3, s[28:31], s32 offen offset:0 nt
s_mov_b64 exec, 1
v_mov_b32 v4, 2
ds_add_u32 v0, v4 offset:1352
s_mov_b64 exec, -1
v_perm_b32 v88, v108, v104, s6
v_perm_b32 v89, v124, v120, s6
v_perm_b32 v90, v108, v104, s7
v_perm_b32 v91, v124, v120, s7
v_perm_b32 v92, v109, v105, s6
v_perm_b32 v93, v125, v121, s6
v_perm_b32 v94, v109, v105, s7
v_perm_b32 v95, v125, v121, s7
v_mfma_f32_16x16x16_bf16 v[24:27], v[16:17], v[88:89], v[24:27]
v_mfma_f32_16x16x16_bf16 v[28:31], v[16:17], v[90:91], v[28:31]
v_mfma_f32_16x16x16_bf16 v[32:35], v[16:17], v[92:93], v[32:35]
v_mfma_f32_16x16x16_bf16 v[36:39], v[16:17], v[94:95], v[36:39]
s_xor_b32 s32, s44, 1318912
s_waitcnt vmcnt(2)
buffer_load_dwordx4 v[140:143], v3, s[28:31], s32 offen offset:0 nt
v_mov_b32 v4, 0
ds_read_b32 v4, v4 offset:1356
s_waitcnt lgkmcnt(0)
v_cmp_eq_u32 vcc, 1, v4
v_perm_b32 v96, v110, v106, s6
v_perm_b32 v97, v126, v122, s6
v_perm_b32 v98, v110, v106, s7
v_perm_b32 v99, v126, v122, s7
v_perm_b32 v100, v111, v107, s6
v_perm_b32 v101, v127, v123, s6
v_perm_b32 v102, v111, v107, s7
v_perm_b32 v103, v127, v123, s7
v_mfma_f32_16x16x16_bf16 v[40:43], v[16:17], v[96:97], v[40:43]
v_mfma_f32_16x16x16_bf16 v[44:47], v[16:17], v[98:99], v[44:47]
v_mfma_f32_16x16x16_bf16 v[48:51], v[16:17], v[100:101], v[48:51]
v_mfma_f32_16x16x16_bf16 v[52:55], v[16:17], v[102:103], v[52:55]
s_xor_b32 s32, s44, 1310720
s_waitcnt vmcnt(2)
s_cbranch_vccnz L_w106
s_waitcnt vmcnt(1)
L_w106:
buffer_load_dwordx4 v[144:147], v3, s[28:31], s32 offen offset:256 nt
s_mov_b64 exec, 1
v_mov_b32 v4, 2
ds_add_u32 v0, v4 offset:1352
s_mov_b64 exec, -1
v_perm_b32 v88, v116, v112, s6
v_perm_b32 v89, v132, v128, s6
v_perm_b32 v90, v116, v112, s7
v_perm_b32 v91, v132, v128, s7
v_perm_b32 v92, v117, v113, s6
v_perm_b32 v93, v133, v129, s6
v_perm_b32 v94, v117, v113, s7
v_perm_b32 v95, v133, v129, s7
v_mfma_f32_16x16x16_bf16 v[56:59], v[16:17], v[88:89], v[56:59]
v_mfma_f32_16x16x16_bf16 v[60:63], v[16:17], v[90:91], v[60:63]
v_mfma_f32_16x16x16_bf16 v[64:67], v[16:17], v[92:93], v[64:67]
v_mfma_f32_16x16x16_bf16 v[68:71], v[16:17], v[94:95], v[68:71]
s_xor_b32 s32, s44, 1318912
s_waitcnt vmcnt(2)
buffer_load_dwordx4 v[148:151], v3, s[28:31], s32 offen offset:256 nt
v_perm_b32 v96, v118, v114, s6
v_perm_b32 v97, v134, v130, s6
v_perm_b32 v98, v118, v114, s7
v_perm_b32 v99, v134, v130, s7
v_perm_b32 v100, v119, v115, s6
v_perm_b32 v101, v135, v131, s6
v_perm_b32 v102, v119, v115, s7
v_perm_b32 v103, v135, v131, s7
v_mfma_f32_16x16x16_bf16 v[72:75], v[16:17], v[96:97], v[72:75]
v_mfma_f32_16x16x16_bf16 v[76:79], v[16:17], v[98:99], v[76:79]
v_mfma_f32_16x16x16_bf16 v[80:83], v[16:17], v[100:101], v[80:83]
v_mfma_f32_16x16x16_bf16 v[84:87], v[16:17], v[102:103], v[84:87]
s_xor_b32 s32, s44, 1441792
s_waitcnt vmcnt(2)
buffer_load_dwordx4 v[152:155], v3, s[28:31], s32 offen offset:0 nt
s_mov_b64 exec, 1
v_mov_b32 v4, 2
ds_add_u32 v0, v4 offset:1352
s_mov_b64 exec, -1
s_xor_b32 s32, s44, 1449984
s_waitcnt vmcnt(2)
buffer_load_dwordx4 v[156:159], v3, s[28:31], s32 offen offset:0 nt
v_mov_b32 v4, 0
ds_read_b32 v4, v4 offset:1356
s_waitcnt lgkmcnt(0)
v_cmp_eq_u32 vcc, 1, v4
s_xor_b32 s32, s44, 1441792
s_waitcnt vmcnt(2)
s_cbranch_vccnz L_w110
s_waitcnt vmcnt(1)
L_w110:
buffer_load_dwordx4 v[160:163], v3, s[28:31], s32 offen offset:256 nt
s_mov_b64 exec, 1
v_mov_b32 v4, 2
ds_add_u32 v0, v4 offset:1352
s_mov_b64 exec, -1
s_xor_b32 s32, s44, 1449984
s_waitcnt vmcnt(2)
buffer_load_dwordx4 v[164:167], v3, s[28:31], s32 offen offset:256 nt
s_xor_b32 s32, s44, 1572864
s_waitcnt vmcnt(2)
buffer_load_dwordx4 v[104:107], v3, s[28:31], s32 offen offset:0 nt
s_mov_b64 exec, 1
v_mov_b32 v4, 2
ds_add_u32 v0, v4 offset:1352
s_mov_b64 exec, -1
v_perm_b32 v88, v140, v136, s6
v_perm_b32 v89, v156, v152, s6
v_perm_b32 v90, v140, v136, s7
v_perm_b32 v91, v156, v152, s7
v_perm_b32 v92, v141, v137, s6
v_perm_b32 v93, v157, v153, s6
v_perm_b32 v94, v141, v137, s7
v_perm_b32 v95, v157, v153, s7
v_mfma_f32_16x16x16_bf16 v[24:27], v[18:19], v[88:89], v[24:27]
v_mfma_f32_16x16x16_bf16 v[28:31], v[18:19], v[90:91], v[28:31]
v_mfma_f32_16x16x16_bf16 v[32:35], v[18:19], v[92:93], v[32:35]
v_mfma_f32_16x16x16_bf16 v[36:39], v[18:19], v[94:95], v[36:39]
s_xor_b32 s32, s44, 1581056
s_waitcnt vmcnt(2)
buffer_load_dwordx4 v[108:111], v3, s[28:31], s32 offen offset:0 nt
v_mov_b32 v4, 0
ds_read_b32 v4, v4 offset:1356
s_waitcnt lgkmcnt(0)
v_cmp_eq_u32 vcc, 1, v4
v_perm_b32 v96, v142, v138, s6
v_perm_b32 v97, v158, v154, s6
v_perm_b32 v98, v142, v138, s7
v_perm_b32 v99, v158, v154, s7
v_perm_b32 v100, v143, v139, s6
v_perm_b32 v101, v159, v155, s6
v_perm_b32 v102, v143, v139, s7
v_perm_b32 v103, v159, v155, s7
v_mfma_f32_16x16x16_bf16 v[40:43], v[18:19], v[96:97], v[40:43]
v_mfma_f32_16x16x16_bf16 v[44:47], v[18:19], v[98:99], v[44:47]
v_mfma_f32_16x16x16_bf16 v[48:51], v[18:19], v[100:101], v[48:51]
v_mfma_f32_16x16x16_bf16 v[52:55], v[18:19], v[102:103], v[52:55]
s_xor_b32 s32, s44, 1703936
s_waitcnt vmcnt(2)
s_cbranch_vccnz L_w114
s_waitcnt vmcnt(1)
L_w114:
buffer_load_dwordx4 v[112:115], v3, s[28:31], s32 offen offset:0 nt
s_mov_b64 exec, 1
v_mov_b32 v4, 2
ds_add_u32 v0, v4 offset:1352
s_mov_b64 exec, -1
v_perm_b32 v88, v148, v144, s6
v_perm_b32 v89, v164, v160, s6
v_perm_b32 v90, v148, v144, s7
v_perm_b32 v91, v164, v160, s7
v_perm_b32 v92, v149, v145, s6
v_perm_b32 v93, v165, v161, s6
v_perm_b32 v94, v149, v145, s7
v_perm_b32 v95, v165, v161, s7
v_mfma_f32_16x16x16_bf16 v[56:59], v[18:19], v[88:89], v[56:59]
v_mfma_f32_16x16x16_bf16 v[60:63], v[18:19], v[90:91], v[60:63]
v_mfma_f32_16x16x16_bf16 v[64:67], v[18:19], v[92:93], v[64:67]
v_mfma_f32_16x16x16_bf16 v[68:71], v[18:19], v[94:95], v[68:71]
s_xor_b32 s32, s44, 1712128
s_waitcnt vmcnt(2)
buffer_load_dwordx4 v[116:119], v3, s[28:31], s32 offen offset:0 nt
v_perm_b32 v96, v150, v146, s6
v_perm_b32 v97, v166, v162, s6
v_perm_b32 v98, v150, v146, s7
v_perm_b32 v99, v166, v162, s7
v_perm_b32 v100, v151, v147, s6
v_perm_b32 v101, v167, v163, s6
v_perm_b32 v102, v151, v147, s7
v_perm_b32 v103, v167, v163, s7
v_mfma_f32_16x16x16_bf16 v[72:75], v[18:19], v[96:97], v[72:75]
v_mfma_f32_16x16x16_bf16 v[76:79], v[18:19], v[98:99], v[76:79]
v_mfma_f32_16x16x16_bf16 v[80:83], v[18:19], v[100:101], v[80:83]
v_mfma_f32_16x16x16_bf16 v[84:87], v[18:19], v[102:103], v[84:87]
s_xor_b32 s32, s44, 1835008
s_waitcnt vmcnt(2)
buffer_load_dwordx4 v[120:123], v3, s[28:31], s32 offen offset:0 nt
s_mov_b64 exec, 1
v_mov_b32 v4, 2
ds_add_u32 v0, v4 offset:1352
s_mov_b64 exec, -1
s_xor_b32 s32, s44, 1843200
s_waitcnt vmcnt(2)
buffer_load_dwordx4 v[124:127], v3, s[28:31], s32 offen offset:0 nt
v_mov_b32 v4, 0
ds_read_b32 v4, v4 offset:1356
s_waitcnt lgkmcnt(0)
v_cmp_eq_u32 vcc, 1, v4
s_xor_b32 s32, s44, 1966080
s_waitcnt vmcnt(2)
s_cbranch_vccnz L_w118
s_waitcnt vmcnt(1)
L_w118:
buffer_load_dwordx4 v[128:131], v3, s[28:31], s32 offen offset:0 nt
s_lshl_b32 s9, s3, 3
v_lshrrev_b32 v5, 5, v0
v_lshl_add_u32 v4, v5, 2, s9
s_mov_b32 s10, 4194304
L_fspin:
ds_read_b32 v6, v4 offset:1280
s_sub_u32 s10, s10, 1
s_cbranch_scc1 L_fok
s_waitcnt lgkmcnt(0)
v_cmp_gt_i32 s[36:37], 0, v6
s_cmp_lg_u64 s[36:37], 0
s_cbranch_scc1 L_fspin
L_fok:
s_setprio 3
v_mov_b32 v4, 0
ds_read_b32 v2, v4 offset:1368
ds_read_b32 v4, v4 offset:1360
s_waitcnt lgkmcnt(0)
v_readfirstlane_b32 s40, v4
v_lshrrev_b32 v4, 4, v1
v_lshrrev_b32 v2, v4, v2
v_and_b32 v2, 1, v2
v_cmp_ne_u32 s[38:39], 0, v2
s_mul_i32 s41, s40, 0x9e3779b1
s_add_u32 s41, s41, 0x7f4a7c15
s_lshr_b32 s41, s41, 16
s_mov_b32 s42, 0x11111111
s_mov_b32 s43, 0x11111111
s_andn2_b64 s[36:37], s[42:43], s[38:39]
s_and_b64 s[38:39], s[38:39], s[42:43]
s_lshl_b32 s9, s3, 11
v_and_b32 v4, 15, v0
v_lshlrev_b32 v4, 5, v4
v_lshl_add_u32 v5, v5, 10, v4
v_add_u32 v5, s9, v5
s_lshl_b32 s9, s45, 11
s_add_u32 s9, s9, 1048576
v_lshlrev_b32 v1, 2, v1
v_add_u32 v2, s9, v1
s_waitcnt lgkmcnt(0)
s_mov_b64 exec, 1
v_mov_b32 v4, 2
ds_add_u32 v0, v4 offset:1352
s_mov_b64 exec, -1
s_xor_b32 s32, s44, 1974272
s_waitcnt vmcnt(2)
buffer_load_dwordx4 v[132:135], v3, s[28:31], s32 offen offset:0 nt
s_xor_b32 s32, s44, 1572864
s_waitcnt vmcnt(2)
buffer_load_dwordx4 v[136:139], v3, s[28:31], s32 offen offset:256 nt
s_xor_b32 s32, s44, 1581056
s_waitcnt vmcnt(2)
buffer_load_dwordx4 v[140:143], v3, s[28:31], s32 offen offset:256 nt
s_xor_b32 s32, s44, 1703936
s_waitcnt vmcnt(2)
s_cbranch_vccnz L_w122
s_waitcnt vmcnt(1)
L_w122:
buffer_load_dwordx4 v[144:147], v3, s[28:31], s32 offen offset:256 nt
v_perm_b32 v88, v108, v104, s6
v_perm_b32 v89, v116, v112, s6
v_perm_b32 v90, v124, v120, s6
v_perm_b32 v91, v132, v128, s6
v_perm_b32 v92, v108, v104, s7
v_perm_b32 v93, v116, v112, s7
v_perm_b32 v94, v124, v120, s7
v_perm_b32 v95, v132, v128, s7
v_mfma_f32_16x16x32_bf16 v[24:27], v[20:23], v[88:91], v[24:27]
s_nop 0
v_mfma_f32_16x16x32_bf16 v[28:31], v[20:23], v[92:95], v[28:31]
s_xor_b32 s32, s44, 1712128
s_waitcnt vmcnt(2)
buffer_load_dwordx4 v[148:151], v3, s[28:31], s32 offen offset:256 nt
v_perm_b32 v96, v109, v105, s6
v_perm_b32 v97, v117, v113, s6
v_perm_b32 v98, v125, v121, s6
v_perm_b32 v99, v133, v129, s6
v_perm_b32 v100, v109, v105, s7
v_perm_b32 v101, v117, v113, s7
v_perm_b32 v102, v125, v121, s7
v_perm_b32 v103, v133, v129, s7
v_mfma_f32_16x16x32_bf16 v[32:35], v[20:23], v[96:99], v[32:35]
s_nop 0
v_mfma_f32_16x16x32_bf16 v[36:39], v[20:23], v[100:103], v[36:39]
s_xor_b32 s32, s44, 1835008
s_waitcnt vmcnt(2)
buffer_load_dwordx4 v[152:155], v3, s[28:31], s32 offen offset:256 nt
v_perm_b32 v88, v110, v106, s6
v_perm_b32 v89, v118, v114, s6
v_perm_b32 v90, v126, v122, s6
v_perm_b32 v91, v134, v130, s6
v_perm_b32 v92, v110, v106, s7
v_perm_b32 v93, v118, v114, s7
v_perm_b32 v94, v126, v122, s7
v_perm_b32 v95, v134, v130, s7
v_mfma_f32_16x16x32_bf16 v[40:43], v[20:23], v[88:91], v[40:43]
s_nop 0
v_mfma_f32_16x16x32_bf16 v[44:47], v[20:23], v[92:95], v[44:47]
s_xor_b32 s32, s44, 1843200
s_waitcnt vmcnt(2)
buffer_load_dwordx4 v[156:159], v3, s[28:31], s32 offen offset:256 nt
v_perm_b32 v96, v111, v107, s6
v_perm_b32 v97, v119, v115, s6
v_perm_b32 v98, v127, v123, s6
v_perm_b32 v99, v135, v131, s6
v_perm_b32 v100, v111, v107, s7
v_perm_b32 v101, v119, v115, s7
v_perm_b32 v102, v127, v123, s7
v_perm_b32 v103, v135, v131, s7
v_mfma_f32_16x16x32_bf16 v[48:51], v[20:23], v[96:99], v[48:51]
s_nop 0
v_mfma_f32_16x16x32_bf16 v[52:55], v[20:23], v[100:103], v[52:55]
s_xor_b32 s32, s44, 1966080
s_waitcnt vmcnt(2)
buffer_load_dwordx4 v[160:163], v3, s[28:31], s32 offen offset:256 nt
s_xor_b32 s32, s44, 1974272
s_waitcnt vmcnt(2)
buffer_load_dwordx4 v[164:167], v3, s[28:31], s32 offen offset:256 nt
s_mov_b64 exec, 1
v_mov_b32 v103, 1
ds_add_u32 v0, v103 offset:1344
s_mov_b64 exec, -1
v_perm_b32 v104, v140, v136, s6
v_perm_b32 v108, v140, v136, s7
v_perm_b32 v112, v141, v137, s6
v_perm_b32 v116, v141, v137, s7
v_perm_b32 v120, v142, v138, s6
v_perm_b32 v124, v142, v138, s7
v_perm_b32 v128, v143, v139, s6
v_perm_b32 v132, v143, v139, s7
v_perm_b32 v105, v148, v144, s6
v_perm_b32 v109, v148, v144, s7
v_perm_b32 v113, v149, v145, s6
v_perm_b32 v117, v149, v145, s7
v_perm_b32 v121, v150, v146, s6
v_perm_b32 v125, v150, v146, s7
v_perm_b32 v129, v151, v147, s6
v_perm_b32 v133, v151, v147, s7
s_waitcnt vmcnt(2)
v_perm_b32 v106, v156, v152, s6
v_perm_b32 v110, v156, v152, s7
v_perm_b32 v114, v157, v153, s6
v_perm_b32 v118, v157, v153, s7
v_perm_b32 v122, v158, v154, s6
v_perm_b32 v126, v158, v154, s7
v_perm_b32 v130, v159, v155, s6
v_perm_b32 v134, v159, v155, s7
v_mul_f32 v88, v6, v24
v_mul_f32 v89, v6, v28
v_mul_f32 v90, v6, v32
v_mul_f32 v91, v6, v36
v_mul_f32 v92, v6, v40
v_mul_f32 v93, v6, v44
v_mul_f32 v94, v6, v48
v_mul_f32 v95, v6, v52
s_mov_b32 exec_lo, 0x0000ffff
s_mov_b32 exec_hi, 0x0000ffff
ds_write_b128 v5, v[88:91] offset:2048
ds_write_b128 v5, v[92:95] offset:2064
s_mov_b64 exec, -1
s_waitcnt vmcnt(0)
v_perm_b32 v107, v164, v160, s6
v_perm_b32 v111, v164, v160, s7
v_perm_b32 v115, v165, v161, s6
v_mfma_f32_16x16x32_bf16 v[56:59], v[20:23], v[104:107], v[56:59]
v_perm_b32 v119, v165, v161, s7
v_mfma_f32_16x16x32_bf16 v[60:63], v[20:23], v[108:111], v[60:63]
v_perm_b32 v123, v166, v162, s6
v_mfma_f32_16x16x32_bf16 v[64:67], v[20:23], v[112:115], v[64:67]
v_perm_b32 v127, v166, v162, s7
v_mfma_f32_16x16x32_bf16 v[68:71], v[20:23], v[116:119], v[68:71]
v_perm_b32 v131, v167, v163, s6
v_mfma_f32_16x16x32_bf16 v[72:75], v[20:23], v[120:123], v[72:75]
v_perm_b32 v135, v167, v163, s7
v_mfma_f32_16x16x32_bf16 v[76:79], v[20:23], v[124:127], v[76:79]
v_mfma_f32_16x16x32_bf16 v[80:83], v[20:23], v[128:131], v[80:83]
s_nop 0
v_mfma_f32_16x16x32_bf16 v[84:87], v[20:23], v[132:135], v[84:87]
s_mov_b32 exec_lo, 0x0000ffff
s_mov_b32 exec_hi, 0x0000ffff
v_mul_f32 v96, v6, v56
v_mul_f32 v97, v6, v60
v_mul_f32 v98, v6, v64
v_mul_f32 v99, v6, v68
ds_write_b128 v5, v[96:99] offset:2560
s_nop 0
v_mul_f32 v100, v6, v72
v_mul_f32 v101, v6, v76
v_mul_f32 v102, v6, v80
v_mul_f32 v103, v6, v84
ds_write_b128 v5, v[100:103] offset:2576
s_mov_b64 exec, -1
v_and_b32 v9, 3, v0
v_mul_u32_u24 v9, 12, v9
v_lshrrev_b64 v[10:11], v9, s[40:41]
v_add_u32 v3, 8388608, v2
s_movk_i32 s9, 0xfff
s_waitcnt lgkmcnt(0)
s_barrier
ds_read2st64_b32 v[24:25], v1 offset0:8 offset1:16
ds_read2st64_b32 v[26:27], v1 offset0:24 offset1:32
ds_read2st64_b32 v[28:29], v1 offset0:40 offset1:48
ds_read2st64_b32 v[30:31], v1 offset0:56 offset1:64
s_waitcnt lgkmcnt(2)
v_add_f32 v24, v24, v25
v_add_f32 v26, v26, v27
v_add_f32 v24, v24, v26
s_waitcnt lgkmcnt(0)
v_add_f32 v28, v28, v29
v_add_f32 v30, v30, v31
v_add_f32 v28, v28, v30
v_add_f32 v8, v24, v28
v_bfi_b32 v8, s9, v10, v8
s_nop 1
v_mov_b32_dpp v9, v8 quad_perm:[1,1,1,1] row_mask:0xf bank_mask:0xf
v_mov_b32_dpp v10, v8 quad_perm:[2,2,2,2] row_mask:0xf bank_mask:0xf
v_mov_b32_dpp v11, v8 quad_perm:[3,3,3,3] row_mask:0xf bank_mask:0xf
s_mov_b64 exec, s[38:39]
s_cbranch_execz L_p1
global_store_dwordx4 v3, v[8:11], s[22:23]
L_p1:
s_mov_b64 exec, s[36:37]
s_cbranch_execz L_p2
global_store_dwordx4 v2, v[8:11], s[22:23] sc1
L_p2:
s_mov_b64 exec, -1
s_branch L_fin
L_helper:
s_setprio 3
s_lshr_b32 s44, s2, 4
s_lshl_b32 s44, s44, 3
s_and_b32 s85, s2, 7
s_add_u32 s85, s85, s44
s_cmp_lt_u32 s85, 14
s_cselect_b32 s87, 1, 0
s_bitcmp1_b32 s2, 3
s_cselect_b32 s86, s87, 0
s_cselect_b32 s87, 0, s87
s_mul_i32 s44, s35, 14
s_add_u32 s44, s44, s85
s_mov_b32 s85, s44
s_sub_u32 s3, s3, 8
s_waitcnt lgkmcnt(0)
s_load_dword s34, s[22:23], 0
s_mov_b32 s6, 0x05040100
s_mov_b32 s7, 0x07060302
s_cmp_ge_u32 s3, 2
s_cbranch_scc1 L_hinit
s_cmp_eq_u32 s3, 0
s_cbranch_scc1 L_gemv
s_cmp_eq_u32 s86, 0
s_cbranch_scc1 L_hinit
L_gemv:
v_mov_b32 v4, 0
ds_write_b32 v4, v4 offset:1364
s_lshl_b32 s9, s35, 3
s_and_b32 s50, s2, 7
s_add_u32 s9, s9, s50
s_lshr_b32 s50, s2, 3
s_lshr_b32 s46, s44, 2
s_and_b32 s47, s44, 3
s_lshl_b32 s48, s45, 9
s_add_u32 s48, s48, 131072
s_lshl_b32 s49, s44, 9
s_add_u32 s49, s49, 262144
s_mov_b32 s38, 1605632
s_mov_b32 s41, 3584
s_cmp_eq_u32 s3, 0
s_cselect_b32 s36, s10, s16
s_cselect_b32 s37, s11, s17
s_cselect_b32 s38, 3670016, s38
s_mov_b32 s39, 0x20000
s_cselect_b32 s41, 8192, s41
s_cselect_b32 s42, s9, s46
s_cselect_b32 s50, s50, s47
s_cselect_b32 s48, s48, s49
v_lshrrev_b32 v4, 1, v0
v_mul_u32_u24 v5, 28, v4
global_load_dwordx4 v[8:11], v5, s[4:5]
global_load_dwordx3 v[12:14], v5, s[4:5] offset:16
v_lshrrev_b32 v4, 3, v0
s_mul_i32 s46, s50, 224
v_mul_u32_u24 v5, 28, v4
v_add_u32 v5, s46, v5
global_load_dwordx4 v[56:59], v5, s[4:5]
global_load_dwordx3 v[60:62], v5, s[4:5] offset:16
s_mul_i32 s43, s41, 14
v_mul_lo_u32 v5, v4, s43
v_lshl_add_u32 v5, v6, 4, v5
s_lshl_b32 s42, s42, 7
s_mul_i32 s46, s50, 112
s_mul_i32 s46, s46, s41
s_add_u32 s42, s42, s46
s_cmp_eq_u32 s3, 0
s_cselect_b64 vcc, -1, 0
buffer_load_dwordx4 v[96:99], v5, s[36:39], s42 offen nt
s_add_u32 s42, s42, s41
buffer_load_dwordx4 v[100:103], v5, s[36:39], s42 offen nt
s_add_u32 s42, s42, s41
buffer_load_dwordx4 v[104:107], v5, s[36:39], s42 offen nt
s_add_u32 s42, s42, s41
buffer_load_dwordx4 v[108:111], v5, s[36:39], s42 offen nt
s_add_u32 s42, s42, s41
buffer_load_dwordx4 v[112:115], v5, s[36:39], s42 offen nt
s_add_u32 s42, s42, s41
buffer_load_dwordx4 v[116:119], v5, s[36:39], s42 offen nt
s_add_u32 s42, s42, s41
buffer_load_dwordx4 v[120:123], v5, s[36:39], s42 offen nt
s_add_u32 s42, s42, s41
buffer_load_dwordx4 v[124:127], v5, s[36:39], s42 offen nt
s_add_u32 s42, s42, s41
buffer_load_dwordx4 v[128:131], v5, s[36:39], s42 offen nt
s_add_u32 s42, s42, s41
buffer_load_dwordx4 v[132:135], v5, s[36:39], s42 offen nt
s_add_u32 s42, s42, s41
buffer_load_dwordx4 v[136:139], v5, s[36:39], s42 offen nt
s_add_u32 s42, s42, s41
buffer_load_dwordx4 v[140:143], v5, s[36:39], s42 offen nt
s_add_u32 s42, s42, s41
buffer_load_dwordx4 v[144:147], v5, s[36:39], s42 offen nt
s_add_u32 s42, s42, s41
buffer_load_dwordx4 v[148:151], v5, s[36:39], s42 offen nt
s_waitcnt vmcnt(16)
v_lshlrev_b32 v16, 16, v8
v_and_b32 v17, 0xffff0000, v8
v_lshlrev_b32 v18, 16, v9
v_and_b32 v19, 0xffff0000, v9
v_lshlrev_b32 v20, 16, v10
v_and_b32 v21, 0xffff0000, v10
v_lshlrev_b32 v22, 16, v11
v_and_b32 v23, 0xffff0000, v11
v_lshlrev_b32 v24, 16, v12
v_and_b32 v25, 0xffff0000, v12
v_lshlrev_b32 v26, 16, v13
v_and_b32 v27, 0xffff0000, v13
v_lshlrev_b32 v28, 16, v14
v_and_b32 v29, 0xffff0000, v14
v_add_f32 v30, v16, v17
v_add_f32 v30, v30, v18
v_add_f32 v30, v30, v19
v_add_f32 v30, v30, v20
v_add_f32 v30, v30, v21
v_add_f32 v30, v30, v22
v_add_f32 v30, v30, v23
v_add_f32 v30, v30, v24
v_add_f32 v30, v30, v25
v_add_f32 v30, v30, v26
v_add_f32 v30, v30, v27
v_add_f32 v30, v30, v28
v_add_f32 v30, v30, v29
s_nop 1
v_add_f32_dpp v30, v30, v30 quad_perm:[2,3,0,1] row_mask:0xf bank_mask:0xf
s_nop 1
v_add_f32_dpp v30, v30, v30 row_ror:4 row_mask:0xf bank_mask:0xf
s_nop 1
v_add_f32_dpp v30, v30, v30 row_ror:8 row_mask:0xf bank_mask:0xf
v_mov_b32 v31, v30
s_nop 1
v_permlane16_swap_b32 v30, v31
v_add_f32 v30, v30, v31
v_mov_b32 v31, v30
s_nop 1
v_permlane32_swap_b32 v30, v31
v_add_f32 v30, v30, v31
v_mul_f32 v30, 0x3b124925, v30
v_sub_f32 v32, v16, v30
v_mul_f32 v33, v32, v32
v_sub_f32 v32, v17, v30
v_fmac_f32 v33, v32, v32
v_sub_f32 v32, v18, v30
v_fmac_f32 v33, v32, v32
v_sub_f32 v32, v19, v30
v_fmac_f32 v33, v32, v32
v_sub_f32 v32, v20, v30
v_fmac_f32 v33, v32, v32
v_sub_f32 v32, v21, v30
v_fmac_f32 v33, v32, v32
v_sub_f32 v32, v22, v30
v_fmac_f32 v33, v32, v32
v_sub_f32 v32, v23, v30
v_fmac_f32 v33, v32, v32
v_sub_f32 v32, v24, v30
v_fmac_f32 v33, v32, v32
v_sub_f32 v32, v25, v30
v_fmac_f32 v33, v32, v32
v_sub_f32 v32, v26, v30
v_fmac_f32 v33, v32, v32
v_sub_f32 v32, v27, v30
v_fmac_f32 v33, v32, v32
v_sub_f32 v32, v28, v30
v_fmac_f32 v33, v32, v32
v_sub_f32 v32, v29, v30
v_fmac_f32 v33, v32, v32
s_nop 1
v_add_f32_dpp v33, v33, v33 quad_perm:[2,3,0,1] row_mask:0xf bank_mask:0xf
s_nop 1
v_add_f32_dpp v33, v33, v33 row_ror:4 row_mask:0xf bank_mask:0xf
s_nop 1
v_add_f32_dpp v33, v33, v33 row_ror:8 row_mask:0xf bank_mask:0xf
v_mov_b32 v31, v33
s_nop 1
v_permlane16_swap_b32 v33, v31
v_add_f32 v33, v33, v31
v_mov_b32 v31, v33
s_nop 1
v_permlane32_swap_b32 v33, v31
v_add_f32 v33, v33, v31
v_mul_f32 v33, 0x3b124925, v33
v_cvt_pk_bf16_f32 v30, v30, v33
v_and_b32 v33, 0xffff0000, v30
v_lshlrev_b32 v30, 16, v30
v_add_f32 v33, 0x3727c5ac, v33
v_cvt_pk_bf16_f32 v33, v33, v33
v_and_b32 v33, 0xffff0000, v33
v_sqrt_f32 v33, v33
s_nop 0
v_cvt_pk_bf16_f32 v33, v33, v33
v_and_b32 v33, 0xffff0000, v33
v_rcp_f32 v33, v33
s_waitcnt vmcnt(14)
v_lshlrev_b32 v16, 16, v56
v_and_b32 v17, 0xffff0000, v56
v_sub_f32 v16, v16, v30
v_sub_f32 v17, v17, v30
v_cvt_pk_bf16_f32 v17, v16, v17
v_lshlrev_b32 v16, 16, v17
v_and_b32 v17, 0xffff0000, v17
v_mul_f32 v16, v16, v33
v_mul_f32 v17, v17, v33
v_cvt_pk_bf16_f32 v8, v16, v17
v_lshlrev_b32 v16, 16, v57
v_and_b32 v17, 0xffff0000, v57
v_sub_f32 v16, v16, v30
v_sub_f32 v17, v17, v30
v_cvt_pk_bf16_f32 v17, v16, v17
v_lshlrev_b32 v16, 16, v17
v_and_b32 v17, 0xffff0000, v17
v_mul_f32 v16, v16, v33
v_mul_f32 v17, v17, v33
v_cvt_pk_bf16_f32 v9, v16, v17
v_lshlrev_b32 v16, 16, v58
v_and_b32 v17, 0xffff0000, v58
v_sub_f32 v16, v16, v30
v_sub_f32 v17, v17, v30
v_cvt_pk_bf16_f32 v17, v16, v17
v_lshlrev_b32 v16, 16, v17
v_and_b32 v17, 0xffff0000, v17
v_mul_f32 v16, v16, v33
v_mul_f32 v17, v17, v33
v_cvt_pk_bf16_f32 v10, v16, v17
v_lshlrev_b32 v16, 16, v59
v_and_b32 v17, 0xffff0000, v59
v_sub_f32 v16, v16, v30
v_sub_f32 v17, v17, v30
v_cvt_pk_bf16_f32 v17, v16, v17
v_lshlrev_b32 v16, 16, v17
v_and_b32 v17, 0xffff0000, v17
v_mul_f32 v16, v16, v33
v_mul_f32 v17, v17, v33
v_cvt_pk_bf16_f32 v11, v16, v17
v_lshlrev_b32 v16, 16, v60
v_and_b32 v17, 0xffff0000, v60
v_sub_f32 v16, v16, v30
v_sub_f32 v17, v17, v30
v_cvt_pk_bf16_f32 v17, v16, v17
v_lshlrev_b32 v16, 16, v17
v_and_b32 v17, 0xffff0000, v17
v_mul_f32 v16, v16, v33
v_mul_f32 v17, v17, v33
v_cvt_pk_bf16_f32 v12, v16, v17
v_lshlrev_b32 v16, 16, v61
v_and_b32 v17, 0xffff0000, v61
v_sub_f32 v16, v16, v30
v_sub_f32 v17, v17, v30
v_cvt_pk_bf16_f32 v17, v16, v17
v_lshlrev_b32 v16, 16, v17
v_and_b32 v17, 0xffff0000, v17
v_mul_f32 v16, v16, v33
v_mul_f32 v17, v17, v33
v_cvt_pk_bf16_f32 v13, v16, v17
v_lshlrev_b32 v16, 16, v62
v_and_b32 v17, 0xffff0000, v62
v_sub_f32 v16, v16, v30
v_sub_f32 v17, v17, v30
v_cvt_pk_bf16_f32 v17, v16, v17
v_lshlrev_b32 v16, 16, v17
v_and_b32 v17, 0xffff0000, v17
v_mul_f32 v16, v16, v33
v_mul_f32 v17, v17, v33
v_cvt_pk_bf16_f32 v14, v16, v17
s_waitcnt vmcnt(12)
v_perm_b32 v48, v100, v96, s6
v_perm_b32 v49, v100, v96, s7
v_perm_b32 v50, v101, v97, s6
v_perm_b32 v51, v101, v97, s7
v_perm_b32 v52, v102, v98, s6
v_perm_b32 v53, v102, v98, s7
v_perm_b32 v54, v103, v99, s6
v_perm_b32 v55, v103, v99, s7
v_dot2_f32_bf16 v40, v48, v8, 0
v_dot2_f32_bf16 v41, v49, v8, 0
v_dot2_f32_bf16 v42, v50, v8, 0
v_dot2_f32_bf16 v43, v51, v8, 0
v_dot2_f32_bf16 v44, v52, v8, 0
v_dot2_f32_bf16 v45, v53, v8, 0
v_dot2_f32_bf16 v46, v54, v8, 0
v_dot2_f32_bf16 v47, v55, v8, 0
s_waitcnt vmcnt(10)
v_perm_b32 v48, v108, v104, s6
v_perm_b32 v49, v108, v104, s7
v_perm_b32 v50, v109, v105, s6
v_perm_b32 v51, v109, v105, s7
v_perm_b32 v52, v110, v106, s6
v_perm_b32 v53, v110, v106, s7
v_perm_b32 v54, v111, v107, s6
v_perm_b32 v55, v111, v107, s7
v_dot2_f32_bf16 v40, v48, v9, v40
v_dot2_f32_bf16 v41, v49, v9, v41
v_dot2_f32_bf16 v42, v50, v9, v42
v_dot2_f32_bf16 v43, v51, v9, v43
v_dot2_f32_bf16 v44, v52, v9, v44
v_dot2_f32_bf16 v45, v53, v9, v45
v_dot2_f32_bf16 v46, v54, v9, v46
v_dot2_f32_bf16 v47, v55, v9, v47
s_waitcnt vmcnt(8)
v_perm_b32 v48, v116, v112, s6
v_perm_b32 v49, v116, v112, s7
v_perm_b32 v50, v117, v113, s6
v_perm_b32 v51, v117, v113, s7
v_perm_b32 v52, v118, v114, s6
v_perm_b32 v53, v118, v114, s7
v_perm_b32 v54, v119, v115, s6
v_perm_b32 v55, v119, v115, s7
v_dot2_f32_bf16 v40, v48, v10, v40
v_dot2_f32_bf16 v41, v49, v10, v41
v_dot2_f32_bf16 v42, v50, v10, v42
v_dot2_f32_bf16 v43, v51, v10, v43
v_dot2_f32_bf16 v44, v52, v10, v44
v_dot2_f32_bf16 v45, v53, v10, v45
v_dot2_f32_bf16 v46, v54, v10, v46
v_dot2_f32_bf16 v47, v55, v10, v47
s_waitcnt vmcnt(6)
v_perm_b32 v48, v124, v120, s6
v_perm_b32 v49, v124, v120, s7
v_perm_b32 v50, v125, v121, s6
v_perm_b32 v51, v125, v121, s7
v_perm_b32 v52, v126, v122, s6
v_perm_b32 v53, v126, v122, s7
v_perm_b32 v54, v127, v123, s6
v_perm_b32 v55, v127, v123, s7
v_dot2_f32_bf16 v40, v48, v11, v40
v_dot2_f32_bf16 v41, v49, v11, v41
v_dot2_f32_bf16 v42, v50, v11, v42
v_dot2_f32_bf16 v43, v51, v11, v43
v_dot2_f32_bf16 v44, v52, v11, v44
v_dot2_f32_bf16 v45, v53, v11, v45
v_dot2_f32_bf16 v46, v54, v11, v46
v_dot2_f32_bf16 v47, v55, v11, v47
s_waitcnt vmcnt(4)
v_perm_b32 v48, v132, v128, s6
v_perm_b32 v49, v132, v128, s7
v_perm_b32 v50, v133, v129, s6
v_perm_b32 v51, v133, v129, s7
v_perm_b32 v52, v134, v130, s6
v_perm_b32 v53, v134, v130, s7
v_perm_b32 v54, v135, v131, s6
v_perm_b32 v55, v135, v131, s7
v_dot2_f32_bf16 v40, v48, v12, v40
v_dot2_f32_bf16 v41, v49, v12, v41
v_dot2_f32_bf16 v42, v50, v12, v42
v_dot2_f32_bf16 v43, v51, v12, v43
v_dot2_f32_bf16 v44, v52, v12, v44
v_dot2_f32_bf16 v45, v53, v12, v45
v_dot2_f32_bf16 v46, v54, v12, v46
v_dot2_f32_bf16 v47, v55, v12, v47
s_waitcnt vmcnt(2)
v_perm_b32 v48, v140, v136, s6
v_perm_b32 v49, v140, v136, s7
v_perm_b32 v50, v141, v137, s6
v_perm_b32 v51, v141, v137, s7
v_perm_b32 v52, v142, v138, s6
v_perm_b32 v53, v142, v138, s7
v_perm_b32 v54, v143, v139, s6
v_perm_b32 v55, v143, v139, s7
v_dot2_f32_bf16 v40, v48, v13, v40
v_dot2_f32_bf16 v41, v49, v13, v41
v_dot2_f32_bf16 v42, v50, v13, v42
v_dot2_f32_bf16 v43, v51, v13, v43
v_dot2_f32_bf16 v44, v52, v13, v44
v_dot2_f32_bf16 v45, v53, v13, v45
v_dot2_f32_bf16 v46, v54, v13, v46
v_dot2_f32_bf16 v47, v55, v13, v47
s_waitcnt vmcnt(0)
v_perm_b32 v48, v148, v144, s6
v_perm_b32 v49, v148, v144, s7
v_perm_b32 v50, v149, v145, s6
v_perm_b32 v51, v149, v145, s7
v_perm_b32 v52, v150, v146, s6
v_perm_b32 v53, v150, v146, s7
v_perm_b32 v54, v151, v147, s6
v_perm_b32 v55, v151, v147, s7
v_dot2_f32_bf16 v40, v48, v14, v40
v_dot2_f32_bf16 v41, v49, v14, v41
v_dot2_f32_bf16 v42, v50, v14, v42
v_dot2_f32_bf16 v43, v51, v14, v43
v_dot2_f32_bf16 v44, v52, v14, v44
v_dot2_f32_bf16 v45, v53, v14, v45
v_dot2_f32_bf16 v46, v54, v14, v46
v_dot2_f32_bf16 v47, v55, v14, v47
s_waitcnt lgkmcnt(0)
s_add_u32 s51, s34, 1
s_mul_i32 s88, s51, 0x9e3779b1
s_add_u32 s88, s88, 0x7f4a7c15
v_permlane32_swap_b32 v40, v44
v_permlane32_swap_b32 v41, v45
v_permlane32_swap_b32 v42, v46
v_permlane32_swap_b32 v43, v47
v_add_f32 v40, v40, v44
v_add_f32 v41, v41, v45
v_add_f32 v42, v42, v46
v_add_f32 v43, v43, v47
v_lshrrev_b32 v4, 4, v0
v_permlane16_swap_b32 v40, v42
v_permlane16_swap_b32 v41, v43
v_add_f32 v40, v40, v42
v_add_f32 v41, v41, v43
v_lshl_add_u32 v4, v6, 2, v4
v_add_f32_dpp v40, v40, v40 row_ror:8 row_mask:0xf bank_mask:0xf
v_add_f32_dpp v42, v41, v41 row_ror:8 row_mask:0xf bank_mask:0xf
v_mov_b32 v41, s51
v_mov_b32 v43, s88
v_lshl_add_u32 v4, v4, 4, s48
s_mov_b32 exec_lo, 0x00ff00ff
s_mov_b32 exec_hi, 0x00ff00ff
global_store_dwordx4 v4, v[40:43], s[22:23] sc1
s_mov_b64 exec, -1
s_cmp_eq_u32 s3, 0
s_cbranch_scc0 L_hinit
s_lshl_b32 s9, s35, 14
s_add_u32 s9, s9, 131072
v_lshl_add_u32 v8, v0, 4, s9
v_add_u32 v9, 4096, v8
v_add_u32 v10, 8192, v8
v_add_u32 v11, 12288, v8
s_mov_b32 s9, 4194304
s_mov_b32 s10, 2000
v_mov_b32 v38, 0
L_qw:
s_sleep 4
ds_read_b32 v39, v38 offset:1364
s_sub_u32 s10, s10, 1
s_cbranch_scc1 L_qwk
s_waitcnt lgkmcnt(0)
v_cmp_ne_u32 vcc, 1, v39
s_cbranch_vccnz L_qw
L_qwk:
s_waitcnt lgkmcnt(0)
s_branch L_gpoll1
L_gpoll:
s_sleep 16
L_gpoll1:
global_load_dwordx4 v[96:99], v8, s[22:23] offset:0 sc1
global_load_dwordx4 v[112:115], v8, s[22:23] offset:1024 sc1
global_load_dwordx4 v[128:131], v8, s[22:23] offset:2048 sc1
global_load_dwordx4 v[144:147], v8, s[22:23] offset:3072 sc1
global_load_dwordx4 v[100:103], v9, s[22:23] offset:0 sc1
global_load_dwordx4 v[116:119], v9, s[22:23] offset:1024 sc1
global_load_dwordx4 v[132:135], v9, s[22:23] offset:2048 sc1
global_load_dwordx4 v[148:151], v9, s[22:23] offset:3072 sc1
global_load_dwordx4 v[104:107], v10, s[22:23] offset:0 sc1
global_load_dwordx4 v[120:123], v10, s[22:23] offset:1024 sc1
global_load_dwordx4 v[136:139], v10, s[22:23] offset:2048 sc1
global_load_dwordx4 v[152:155], v10, s[22:23] offset:3072 sc1
global_load_dwordx4 v[108:111], v11, s[22:23] offset:0 sc1
global_load_dwordx4 v[124:127], v11, s[22:23] offset:1024 sc1
global_load_dwordx4 v[140:143], v11, s[22:23] offset:2048 sc1
global_load_dwordx4 v[156:159], v11, s[22:23] offset:3072 sc1
s_sub_u32 s9, s9, 1
s_cbranch_scc1 L_gok
v_mov_b32 v16, 0
s_waitcnt vmcnt(15)
v_xor_b32 v17, s51, v97
v_xor_b32 v18, s88, v99
v_or3_b32 v16, v16, v17, v18
s_waitcnt vmcnt(14)
v_xor_b32 v17, s51, v113
v_xor_b32 v18, s88, v115
v_or3_b32 v16, v16, v17, v18
s_waitcnt vmcnt(13)
v_xor_b32 v17, s51, v129
v_xor_b32 v18, s88, v131
v_or3_b32 v16, v16, v17, v18
s_waitcnt vmcnt(12)
v_xor_b32 v17, s51, v145
v_xor_b32 v18, s88, v147
v_or3_b32 v16, v16, v17, v18
s_waitcnt vmcnt(11)
v_xor_b32 v17, s51, v101
v_xor_b32 v18, s88, v103
v_or3_b32 v16, v16, v17, v18
s_waitcnt vmcnt(10)
v_xor_b32 v17, s51, v117
v_xor_b32 v18, s88, v119
v_or3_b32 v16, v16, v17, v18
s_waitcnt vmcnt(9)
v_xor_b32 v17, s51, v133
v_xor_b32 v18, s88, v135
v_or3_b32 v16, v16, v17, v18
s_waitcnt vmcnt(8)
v_xor_b32 v17, s51, v149
v_xor_b32 v18, s88, v151
v_or3_b32 v16, v16, v17, v18
s_waitcnt vmcnt(7)
v_xor_b32 v17, s51, v105
v_xor_b32 v18, s88, v107
v_or3_b32 v16, v16, v17, v18
s_waitcnt vmcnt(6)
v_xor_b32 v17, s51, v121
v_xor_b32 v18, s88, v123
v_or3_b32 v16, v16, v17, v18
s_waitcnt vmcnt(5)
v_xor_b32 v17, s51, v137
v_xor_b32 v18, s88, v139
v_or3_b32 v16, v16, v17, v18
s_waitcnt vmcnt(4)
v_xor_b32 v17, s51, v153
v_xor_b32 v18, s88, v155
v_or3_b32 v16, v16, v17, v18
s_waitcnt vmcnt(3)
v_xor_b32 v17, s51, v109
v_xor_b32 v18, s88, v111
v_or3_b32 v16, v16, v17, v18
s_waitcnt vmcnt(2)
v_xor_b32 v17, s51, v125
v_xor_b32 v18, s88, v127
v_or3_b32 v16, v16, v17, v18
s_waitcnt vmcnt(1)
v_xor_b32 v17, s51, v141
v_xor_b32 v18, s88, v143
v_or3_b32 v16, v16, v17, v18
s_waitcnt vmcnt(0)
v_xor_b32 v17, s51, v157
v_xor_b32 v18, s88, v159
v_or3_b32 v16, v16, v17, v18
v_cmp_ne_u32 vcc, 0, v16
s_cbranch_vccnz L_gpoll
L_gok:
s_waitcnt vmcnt(0)
v_lshlrev_b32 v4, 2, v0
v_add_f32 v96, v96, v100
v_add_f32 v98, v98, v102
v_add_f32 v104, v104, v108
v_add_f32 v106, v106, v110
v_add_f32 v96, v96, v104
v_add_f32 v98, v98, v106
v_cvt_pk_bf16_f32 v96, v96, v98
ds_write_b32 v4, v96 offset:0
v_add_f32 v112, v112, v116
v_add_f32 v114, v114, v118
v_add_f32 v120, v120, v124
v_add_f32 v122, v122, v126
v_add_f32 v112, v112, v120
v_add_f32 v114, v114, v122
v_cvt_pk_bf16_f32 v112, v112, v114
ds_write_b32 v4, v112 offset:256
v_add_f32 v128, v128, v132
v_add_f32 v130, v130, v134
v_add_f32 v136, v136, v140
v_add_f32 v138, v138, v142
v_add_f32 v128, v128, v136
v_add_f32 v130, v130, v138
v_cvt_pk_bf16_f32 v128, v128, v130
ds_write_b32 v4, v128 offset:512
v_add_f32 v144, v144, v148
v_add_f32 v146, v146, v150
v_add_f32 v152, v152, v156
v_add_f32 v154, v154, v158
v_add_f32 v144, v144, v152
v_add_f32 v146, v146, v154
v_cvt_pk_bf16_f32 v144, v144, v146
ds_write_b32 v4, v144 offset:768
s_branch L_hbar
L_hinit:
v_lshlrev_b32 v4, 2, v0
v_cmp_gt_u32 vcc, 16, v0
v_mov_b32 v5, 0
v_mov_b32 v8, -1
v_cndmask_b32 v5, v5, v8, vcc
s_mov_b64 exec, 0xfffff
ds_write_b32 v4, v5 offset:1280
s_mov_b64 exec, -1
L_hbar:
s_waitcnt lgkmcnt(0)
s_add_u32 s34, s34, 1
s_mul_i32 s88, s34, 0x9e3779b1
s_add_u32 s88, s88, 0x7f4a7c15
v_mov_b32 v4, 0
v_mov_b32 v5, s34
ds_write_b32 v4, v5 offset:1360
s_waitcnt lgkmcnt(0)
s_barrier
s_mul_i32 s9, s85, 14336
s_cmp_lg_u32 s87, 0
s_cselect_b32 s9, s9, 0
s_cselect_b32 s42, 14336, 0
s_add_u32 s40, s18, s9
s_addc_u32 s41, s19, 0
s_mov_b32 s43, 0x20000
s_mul_i32 s9, s45, 14336
s_add_u32 s36, s12, s9
s_addc_u32 s37, s13, 0
s_mov_b32 s38, 14336
s_mov_b32 s39, 0x20000
v_lshrrev_b32 v60, 4, v0
v_and_b32 v61, 15, v0
s_lshl_b32 s9, s3, 8
v_mul_u32_u24 v2, 3584, v60
v_lshl_add_u32 v3, v61, 4, s9
v_add_u32 v2, v2, v3
v_cmp_gt_u32 vcc, 896, v3
v_mov_b32 v3, 0x100000
s_mov_b64 s[52:53], vcc
v_cndmask_b32 v2, v3, v2, vcc
s_cmp_eq_u32 s3, 3
s_cselect_b32 s9, 3, 4
v_lshlrev_b32 v1, s9, v60
v_add_u32 v1, v1, v61
s_lshl_b32 s9, s3, 6
v_add_u32 v1, s9, v1
s_lshl_b32 s9, s45, 2
s_add_u32 s9, s9, s3
s_cmp_eq_u32 s9, 3
s_cbranch_scc0 L_noprobe
v_lshrrev_b32 v8, 1, v0
v_mul_u32_u24 v8, 0x4100, v8
v_and_b32 v9, 1, v0
v_lshl_add_u32 v8, v9, 13, v8
v_add_u32 v8, 3145728, v8
v_mov_b32 v9, 1
s_mov_b64 exec, 4095
global_store_dword v8, v9, s[22:23] sc1
s_mov_b64 exec, -1
s_waitcnt vmcnt(0)
s_mov_b32 s60, 3145728
s_mov_b32 s61, 0
s_mov_b32 s62, 5
s_load_dword s63, s[22:23], s60
s_waitcnt lgkmcnt(0)
L_probe:
s_add_u32 s60, s60, 0x4100
s_add_u32 s9, s60, 0x2000
s_mov_b32 s64, 0
s_mov_b32 s66, 2000
s_load_dword s64, s[22:23], s60
L_pw0:
s_sub_u32 s66, s66, 1
s_cbranch_scc1 L_pd0
s_cmp_eq_u32 s64, 0
s_cbranch_scc1 L_pw0
L_pd0:
s_waitcnt lgkmcnt(0)
s_mov_b32 s64, 0
s_mov_b32 s67, 2000
s_load_dword s64, s[22:23], s9
L_pw1:
s_sub_u32 s67, s67, 1
s_cbranch_scc1 L_pd1
s_cmp_eq_u32 s64, 0
s_cbranch_scc1 L_pw1
L_pd1:
s_waitcnt lgkmcnt(0)
s_cmp_lt_i32 s66, s67
s_addc_u32 s61, s61, 0
s_sub_u32 s62, s62, 1
s_cmp_gt_u32 s62, 0
s_cbranch_scc1 L_probe
s_getreg_b32 s9, hwreg(HW_REG_XCC_ID)
s_bfe_u32 s9, s9, 0x10002
s_cmp_gt_u32 s61, 2
s_cselect_b32 s10, 1, 0
s_xor_b32 s9, s9, s10
v_mov_b32 v8, s9
v_mov_b32 v9, s34
v_mov_b32 v10, s61
v_mov_b32 v11, s88
v_mov_b32 v12, 507904
s_mov_b64 exec, 1
global_store_dwordx4 v12, v[8:11], s[22:23] sc1
s_mov_b64 exec, -1
L_noprobe:
s_cmp_eq_u32 s3, 2
s_cbranch_scc0 L_noloc
s_lshl_b32 s9, s35, 8
s_add_u32 s9, s9, 458752
v_min_u32 v8, 63, v0
v_and_b32 v8, 31, v8
v_lshl_add_u32 v8, v8, 2, s9
s_lshl_b32 s10, s2, 2
s_add_u32 s9, s9, s10
v_mov_b32 v9, s9
s_lshl_b32 s60, s34, 12
v_mov_b32 v15, 0
s_mov_b32 s61, 4000
L_loc:
s_sleep 8
ds_read_b32 v10, v15 offset:1352
s_waitcnt lgkmcnt(0)
v_or_b32 v11, s60, v10
s_mov_b64 exec, 1
global_store_dword v9, v11, s[22:23]
s_mov_b64 exec, -1
global_load_dword v12, v8, s[22:23] sc1
s_waitcnt vmcnt(0)
ds_read_b32 v10, v15 offset:1352
v_xor_b32 v12, s60, v12
v_mov_b32 v13, v12
v_cmp_gt_u32 vcc, 0x1000, v12
v_and_b32 v11, 0xfff, v11
s_nop 0
v_cndmask_b32 v12, v11, v12, vcc
v_sub_u32 v12, v12, v11
s_nop 1
v_add_u32_dpp v12, v12, v12 quad_perm:[1,0,3,2] row_mask:0xf bank_mask:0xf
s_nop 1
v_add_u32_dpp v12, v12, v12 quad_perm:[2,3,0,1] row_mask:0xf bank_mask:0xf
s_nop 1
v_add_u32_dpp v12, v12, v12 row_ror:4 row_mask:0xf bank_mask:0xf
s_nop 1
v_add_u32_dpp v12, v12, v12 row_ror:8 row_mask:0xf bank_mask:0xf
s_waitcnt lgkmcnt(0)
v_readlane_b32 s62, v12, 0
v_readlane_b32 s63, v12, 16
v_readfirstlane_b32 s64, v10
s_add_u32 s62, s62, s63
s_cmp_gt_i32 s62, 0
s_cselect_b32 s63, 1, 0
v_mov_b32 v14, s63
ds_write_b32 v15, v14 offset:1356
s_sub_u32 s61, s61, 1
s_cbranch_scc1 L_noloc
s_cmp_lt_u32 s64, 680
s_cbranch_scc1 L_loc
L_noloc:
s_cmp_eq_u32 s3, 1
s_cbranch_scc0 L_noml
s_mov_b32 s10, 4194304
v_mov_b32 v38, 0
L_cw:
s_sleep 4
ds_read_b32 v39, v38 offset:1344
s_sub_u32 s10, s10, 1
s_cbranch_scc1 L_cwk
s_waitcnt lgkmcnt(0)
v_cmp_gt_u32 vcc, 8, v39
s_cbranch_vccnz L_cw
L_cwk:
s_waitcnt lgkmcnt(0)
v_lshrrev_b32 v4, 5, v0
v_lshlrev_b32 v5, 5, v4
v_lshl_add_u32 v5, v6, 2, v5
ds_read_b32 v20, v5 offset:1152
ds_read_b32 v21, v5 offset:1216
s_lshl_b32 s9, s45, 5
s_add_u32 s9, s9, 393216
v_lshl_add_u32 v28, v4, 4, s9
s_lshl_b32 s9, s35, 10
s_add_u32 s9, s9, 393216
v_and_b32 v29, 31, v0
v_lshlrev_b32 v29, 5, v29
v_lshl_add_u32 v29, v4, 4, v29
v_add_u32 v29, s9, v29
s_getreg_b32 s11, hwreg(HW_REG_XCC_ID)
s_and_b32 s11, s11, 15
s_xor_b32 s9, s11, s88
v_mov_b32 v25, s34
v_mov_b32 v27, s9
s_waitcnt lgkmcnt(0)
v_mov_b32 v24, v20
s_nop 1
v_max_f32_dpp v24, v24, v24 quad_perm:[1,0,3,2] row_mask:0xf bank_mask:0xf
s_nop 1
v_max_f32_dpp v24, v24, v24 quad_perm:[2,3,0,1] row_mask:0xf bank_mask:0xf
s_nop 1
v_max_f32_dpp v24, v24, v24 row_half_mirror row_mask:0xf bank_mask:0xf
v_sub_f32 v26, v20, v24
v_exp_f32 v26, v26
s_nop 0
v_mul_f32 v26, v26, v21
s_nop 1
v_add_f32_dpp v26, v26, v26 quad_perm:[1,0,3,2] row_mask:0xf bank_mask:0xf
s_nop 1
v_add_f32_dpp v26, v26, v26 quad_perm:[2,3,0,1] row_mask:0xf bank_mask:0xf
s_nop 1
v_add_f32_dpp v26, v26, v26 row_half_mirror row_mask:0xf bank_mask:0xf
s_mov_b32 exec_lo, 1
s_mov_b32 exec_hi, 1
global_store_dwordx4 v28, v[24:27], s[22:23] sc1
s_mov_b64 exec, -1
s_mov_b32 s10, 4194304
s_and_b32 s46, s85, 3
s_andn2_b32 s50, s85, 3
s_lshl_b32 s50, s50, 9
s_lshl_b32 s46, s46, 7
s_add_u32 s50, s50, s46
s_add_u32 s50, s50, 262144
s_cmp_lg_u32 s87, 0
s_cselect_b32 s50, s50, 262144
v_lshrrev_b32 v12, 4, v0
v_lshlrev_b32 v12, 9, v12
v_lshl_add_u32 v12, v6, 4, v12
v_add_u32 v12, s50, v12
s_mov_b32 s10, 4194304
v_mov_b32 v38, 0
L_mw:
s_sleep 4
ds_read_b32 v39, v38 offset:1348
s_sub_u32 s10, s10, 1
s_cbranch_scc1 L_mwk
s_waitcnt lgkmcnt(0)
v_cmp_gt_u32 vcc, 1, v39
s_cbranch_vccnz L_mw
L_mwk:
s_waitcnt lgkmcnt(0)
s_mov_b32 s10, 4194304
s_branch L_mlp1
L_mlp:
s_sleep 16
L_mlp1:
global_load_dwordx4 v[32:35], v29, s[22:23] sc1
global_load_dwordx4 v[8:11], v12, s[22:23] sc1
v_mov_b32 v15, 507904
global_load_dwordx4 v[16:19], v15, s[22:23] sc1
s_sub_u32 s10, s10, 1
s_cbranch_scc1 L_mlk
s_waitcnt vmcnt(0)
v_xor_b32 v36, s34, v33
v_xor_b32 v37, s88, v35
v_and_or_b32 v36, v37, -16, v36
v_xor_b32 v13, s34, v9
v_xor_b32 v14, s88, v11
v_or3_b32 v36, v36, v13, v14
v_xor_b32 v13, s34, v17
v_xor_b32 v14, s88, v19
v_or3_b32 v36, v36, v13, v14
v_cmp_ne_u32 vcc, 0, v36
s_cbranch_vccnz L_mlp
L_mlk:
s_waitcnt vmcnt(0)
v_mov_b32 v24, v32
v_cmp_eq_u32 vcc, s9, v35
v_mov_b32 v36, 0
s_nop 0
v_mov_b32 v37, vcc_lo
ds_write_b32 v36, v37 offset:1368
v_and_b32 v16, 1, v16
v_lshlrev_b32 v16, 13, v16
ds_write_b32 v36, v16 offset:1372
v_mov_b32 v13, v8
s_nop 1
v_permlane16_swap_b32 v8, v13
v_add_f32 v8, v8, v13
v_mov_b32 v13, v8
s_nop 1
v_permlane32_swap_b32 v8, v13
v_add_f32 v8, v8, v13
v_mov_b32 v13, v10
s_nop 1
v_permlane16_swap_b32 v10, v13
v_add_f32 v10, v10, v13
v_mov_b32 v13, v10
s_nop 1
v_permlane32_swap_b32 v10, v13
v_add_f32 v10, v10, v13
v_max_f32 v8, 0, v8
v_max_f32 v10, 0, v10
v_cvt_pk_bf16_f32 v8, v8, v10
v_lshlrev_b32 v9, 2, v0
s_mov_b64 exec, 0xff
ds_write_b32 v9, v8 offset:1024
s_mov_b64 exec, -1
s_nop 1
v_max_f32_dpp v24, v24, v24 quad_perm:[1,0,3,2] row_mask:0xf bank_mask:0xf
s_nop 1
v_max_f32_dpp v24, v24, v24 quad_perm:[2,3,0,1] row_mask:0xf bank_mask:0xf
s_nop 1
v_max_f32_dpp v24, v24, v24 row_ror:4 row_mask:0xf bank_mask:0xf
s_nop 1
v_max_f32_dpp v24, v24, v24 row_ror:8 row_mask:0xf bank_mask:0xf
v_mov_b32 v36, v24
s_nop 1
v_permlane16_swap_b32 v24, v36
v_max_f32 v24, v24, v36
v_sub_f32 v26, v32, v24
v_exp_f32 v26, v26
s_nop 0
v_mul_f32 v26, v26, v34
s_nop 1
v_add_f32_dpp v26, v26, v26 quad_perm:[1,0,3,2] row_mask:0xf bank_mask:0xf
s_nop 1
v_add_f32_dpp v26, v26, v26 quad_perm:[2,3,0,1] row_mask:0xf bank_mask:0xf
s_nop 1
v_add_f32_dpp v26, v26, v26 row_ror:4 row_mask:0xf bank_mask:0xf
s_nop 1
v_add_f32_dpp v26, v26, v26 row_ror:8 row_mask:0xf bank_mask:0xf
v_mov_b32 v36, v26
s_nop 1
v_permlane16_swap_b32 v26, v36
v_add_f32 v26, v26, v36
v_sub_f32 v20, v20, v24
v_exp_f32 v20, v20
v_rcp_f32 v26, v26
s_nop 0
v_mul_f32 v20, v20, v26
v_and_b32 v20, 0x7fffffff, v20
v_lshlrev_b32 v5, 2, v4
v_lshl_add_u32 v5, v6, 3, v5
s_mov_b32 exec_lo, 0xff
s_mov_b32 exec_hi, 0xff
ds_write_b32 v5, v20 offset:1280
s_mov_b64 exec, -1
L_noml:
s_lshl_b32 s9, s35, 16
s_lshl_b32 s10, s2, 6
s_add_u32 s9, s9, s10
s_add_u32 s9, s9, 1048576
v_lshlrev_b32 v40, 11, v61
v_lshl_add_u32 v40, v60, 4, v40
v_add_u32 v40, s9, v40
v_add_u32 v41, 32768, v40
v_mul_u32_u24 v62, 2341, v1
v_lshrrev_b32 v62, 16, v62
s_lshr_b32 s9, s45, 3
s_lshl_b32 s9, s9, 14
s_and_b32 s10, s45, 7
s_lshl_b32 s10, s10, 10
s_add_u32 s9, s9, s10
s_add_u32 s9, s9, 2097152
v_lshlrev_b32 v44, 3, v1
v_lshl_add_u32 v44, v62, 5, v44
v_and_b32 v44, 1023, v44
v_add_u32 v44, s9, v44
v_bfe_u32 v53, v62, 2, 1
v_xor_b32 v53, 0, v53
v_lshl_add_u32 v44, v53, 13, v44
s_mov_b32 s70, s34
s_lshr_b32 s71, s88, 16
s_lshr_b64 s[72:73], s[70:71], 12
s_lshr_b64 s[74:75], s[70:71], 24
s_lshr_b64 s[80:81], s[70:71], 36
v_and_b32 v46, 1, v1
v_mul_u32_u24 v46, 24, v46
v_lshrrev_b64 v[46:47], v46, s[70:71]
v_lshrrev_b32 v47, 12, v46
v_mov_b32 v59, 0xfff
v_mov_b32 v74, 0x800
s_mul_i32 s46, s35, 28
s_min_u32 s9, s2, 13
s_lshl_b32 s9, s9, 1
s_add_u32 s46, s46, s9
s_cmp_ge_u32 s46, 192
s_cselect_b32 s9, 3, 4
s_cselect_b32 s10, 7, 15
s_and_b32 s47, s46, 63
s_lshr_b32 s9, s47, s9
s_and_b32 s10, s46, s10
s_andn2_b32 s47, s46, 63
s_lshl_b32 s10, s10, 2
s_add_u32 s47, s47, s10
s_add_u32 s47, s47, s9
s_lshl_b32 s47, s47, 2
v_lshrrev_b32 v63, 5, v0
v_lshl_add_u32 v72, v63, 4, s47
v_and_b32 v73, 1, v60
v_lshl_add_u32 v73, v73, 1, v72
global_load_ushort v73, v73, s[4:5]
s_lshl_b32 s9, s46, 3
s_lshl_b32 s10, s35, 5
s_add_u32 s9, s9, s10
s_and_b32 s9, s9, 1023
s_lshl_b32 s10, s3, 17
s_add_u32 s9, s9, s10
s_lshr_b32 s10, s35, 2
s_xor_b32 s10, s10, 0
s_lshl_b32 s10, s10, 13
s_add_u32 s9, s9, s10
s_add_u32 s9, s9, 2097152
v_lshrrev_b32 v48, 3, v0
v_lshlrev_b32 v48, 14, v48
v_lshl_add_u32 v48, v6, 10, v48
v_add_u32 v48, s9, v48
s_mov_b32 s10, 4194304
v_mov_b32 v38, 0
L_xw:
s_sleep 4
ds_read_b32 v39, v38 offset:1280
s_sub_u32 s10, s10, 1
s_cbranch_scc1 L_xwk
s_waitcnt lgkmcnt(0)
v_cmp_gt_i32 vcc, 0, v39
s_cbranch_vccnz L_xw
L_xwk:
s_waitcnt lgkmcnt(0)
ds_read_b32 v53, v38 offset:1372
s_waitcnt lgkmcnt(0)
v_xor_b32 v44, v44, v53
v_xor_b32 v48, v48, v53
ds_read_b32 v39, v38 offset:1368
v_add_u32 v45, 8388608, v44
s_waitcnt lgkmcnt(0)
v_lshrrev_b32 v53, v61, v39
v_bfe_u32 v54, v53, 0, 1
v_lshl_add_u32 v40, v54, 23, v40
v_bfe_u32 v54, v53, 16, 1
v_lshl_add_u32 v41, v54, 23, v41
v_and_b32 v53, 31, v0
v_lshrrev_b32 v53, v53, v39
v_and_b32 v53, 1, v53
s_lshl_b32 s9, s3, 1
v_add_u32 v55, s9, v63
v_cmp_eq_u32 vcc, s35, v55
v_mov_b32 v56, 0
s_nop 0
v_cndmask_b32 v55, v56, v53, vcc
v_lshl_add_u32 v48, v55, 23, v48
s_mul_i32 s9, s35, 28
v_subrev_u32 v53, s9, v1
v_lshrrev_b32 v53, 1, v53
v_lshrrev_b32 v54, v53, v39
v_and_b32 v54, 1, v54
v_cmp_eq_u32 vcc, s35, v62
v_cmp_ne_u32 s[76:77], 0, v54
s_and_b64 s[76:77], s[76:77], vcc
s_and_b32 s52, s52, 0x55555555
s_and_b32 s53, s53, 0x55555555
s_and_b64 s[76:77], s[76:77], s[52:53]
s_andn2_b64 s[78:79], s[52:53], s[76:77]
v_lshlrev_b32 v58, 4, v60
s_lshl_b32 s9, s3, 2
v_add_u32 v57, s9, v58
s_waitcnt vmcnt(0)
v_lshlrev_b32 v73, 16, v73
v_lshlrev_b32 v4, 3, v60
ds_read_b64 v[8:9], v4 offset:1024
v_mov_b32 v64, 0
v_mov_b32 v16, 0
v_mov_b32 v65, 0
v_mov_b32 v17, 0
v_mov_b32 v66, 0
v_mov_b32 v18, 0
v_mov_b32 v67, 0
v_mov_b32 v19, 0
v_mov_b32 v68, 0
v_mov_b32 v20, 0
v_mov_b32 v69, 0
v_mov_b32 v21, 0
v_mov_b32 v70, 0
v_mov_b32 v22, 0
v_mov_b32 v71, 0
v_mov_b32 v23, 0
s_waitcnt lgkmcnt(0)
v_mov_b32_dpp v64, v8 quad_perm:[0,0,0,0] row_mask:0xf bank_mask:1
v_mov_b32_dpp v65, v9 quad_perm:[0,0,0,0] row_mask:0xf bank_mask:1
v_mov_b32_dpp v66, v8 quad_perm:[0,0,0,0] row_mask:0xf bank_mask:2
v_mov_b32_dpp v67, v9 quad_perm:[0,0,0,0] row_mask:0xf bank_mask:2
v_mov_b32_dpp v68, v8 quad_perm:[0,0,0,0] row_mask:0xf bank_mask:4
v_mov_b32_dpp v69, v9 quad_perm:[0,0,0,0] row_mask:0xf bank_mask:4
v_mov_b32_dpp v70, v8 quad_perm:[0,0,0,0] row_mask:0xf bank_mask:8
v_mov_b32_dpp v71, v9 quad_perm:[0,0,0,0] row_mask:0xf bank_mask:8
s_mov_b32 s10, 4194304
v_mov_b32 v38, 0
L_ww:
s_sleep 1
ds_read_b32 v39, v38 offset:1344
s_sub_u32 s10, s10, 1
s_cbranch_scc1 L_wwk
s_waitcnt lgkmcnt(0)
v_cmp_gt_u32 vcc, 16, v39
s_cbranch_vccnz L_ww
L_wwk:
s_waitcnt lgkmcnt(0)
s_cmp_lg_u32 s87, 0
s_cbranch_scc0 L_now2
buffer_load_dwordx4 v[112:115], v2, s[40:43], 0 offen offset:0 nt
buffer_load_dwordx4 v[116:119], v2, s[40:43], 0 offen offset:896 nt
buffer_load_dwordx4 v[120:123], v2, s[40:43], 0 offen offset:1792 nt
buffer_load_dwordx4 v[124:127], v2, s[40:43], 0 offen offset:2688 nt
L_now2:
buffer_load_dwordx4 v[96:99], v2, s[36:39], 0 offen offset:0 nt
buffer_load_dwordx4 v[100:103], v2, s[36:39], 0 offen offset:896 nt
buffer_load_dwordx4 v[104:107], v2, s[36:39], 0 offen offset:1792 nt
buffer_load_dwordx4 v[108:111], v2, s[36:39], 0 offen offset:2688 nt
s_setprio 0
s_mov_b64 s[56:57], -1
s_mov_b64 s[58:59], -1
s_mov_b32 s10, 4194304
s_waitcnt lgkmcnt(0)
s_barrier
s_waitcnt vmcnt(0)
global_load_dwordx4 v[24:27], v40, s[22:23] sc1
global_load_dwordx4 v[28:31], v41, s[22:23] sc1
s_cmp_lg_u32 s87, 0
s_cbranch_scc0 L_noffn
v_perm_b32 v128, v116, v112, s6
v_perm_b32 v129, v124, v120, s6
v_perm_b32 v130, v117, v113, s6
v_perm_b32 v131, v125, v121, s6
v_perm_b32 v132, v118, v114, s6
v_perm_b32 v133, v126, v122, s6
v_perm_b32 v134, v119, v115, s6
v_perm_b32 v135, v127, v123, s6
v_perm_b32 v136, v116, v112, s7
v_perm_b32 v137, v124, v120, s7
v_perm_b32 v138, v117, v113, s7
v_perm_b32 v139, v125, v121, s7
v_perm_b32 v140, v118, v114, s7
v_perm_b32 v141, v126, v122, s7
v_perm_b32 v142, v119, v115, s7
v_perm_b32 v143, v127, v123, s7
s_nop 0
v_mfma_f32_16x16x32_bf16 v[16:19], v[64:67], v[128:131], v[16:19]
v_mfma_f32_16x16x32_bf16 v[20:23], v[64:67], v[136:139], v[20:23]
v_mfma_f32_16x16x32_bf16 v[16:19], v[68:71], v[132:135], v[16:19]
v_mfma_f32_16x16x32_bf16 v[20:23], v[68:71], v[140:143], v[20:23]
L_noffn:
v_perm_b32 v128, v100, v96, s6
v_perm_b32 v129, v108, v104, s6
v_perm_b32 v130, v101, v97, s6
v_perm_b32 v131, v109, v105, s6
v_perm_b32 v132, v102, v98, s6
v_perm_b32 v133, v110, v106, s6
v_perm_b32 v134, v103, v99, s6
v_perm_b32 v135, v111, v107, s6
v_perm_b32 v136, v100, v96, s7
v_perm_b32 v137, v108, v104, s7
v_perm_b32 v138, v101, v97, s7
v_perm_b32 v139, v109, v105, s7
v_perm_b32 v140, v102, v98, s7
v_perm_b32 v141, v110, v106, s7
v_perm_b32 v142, v103, v99, s7
v_perm_b32 v143, v111, v107, s7
s_branch L_h1c
L_h1:
s_mov_b64 exec, s[56:57]
s_cbranch_execz L_h1s0
global_load_dwordx4 v[24:27], v40, s[22:23] sc1
L_h1s0:
s_mov_b64 exec, s[58:59]
s_cbranch_execz L_h1s1
global_load_dwordx4 v[28:31], v41, s[22:23] sc1
L_h1s1:
s_mov_b64 exec, -1
s_sub_u32 s10, s10, 1
s_cbranch_scc1 L_h1k
L_h1c:
s_waitcnt vmcnt(0)
v_xor_b32 v32, s70, v24
v_xor_b32 v34, s70, v28
v_bitop3_b32 v32, v25, s72, v32 bitop3:0xbe
v_bitop3_b32 v34, v29, s72, v34 bitop3:0xbe
v_bitop3_b32 v32, v26, s74, v32 bitop3:0xbe
v_bitop3_b32 v34, v30, s74, v34 bitop3:0xbe
v_bitop3_b32 v32, v27, s80, v32 bitop3:0xbe
v_bitop3_b32 v34, v31, s80, v34 bitop3:0xbe
v_lshlrev_b32 v32, 20, v32
v_lshlrev_b32 v34, 20, v34
v_cmp_ne_u32 s[56:57], 0, v32
v_cmp_ne_u32 s[58:59], 0, v34
s_or_b64 s[64:65], s[56:57], s[58:59]
s_cbranch_scc1 L_h1
L_h1k:
s_waitcnt vmcnt(0)
v_bfi_b32 v24, v59, v74, v24
v_bfi_b32 v25, v59, v74, v25
v_bfi_b32 v26, v59, v74, v26
v_bfi_b32 v27, v59, v74, v27
v_bfi_b32 v28, v59, v74, v28
v_bfi_b32 v29, v59, v74, v29
v_bfi_b32 v30, v59, v74, v30
v_bfi_b32 v31, v59, v74, v31
v_add_f32 v24, v24, v28
v_add_f32 v25, v25, v29
v_add_f32 v26, v26, v30
v_add_f32 v27, v27, v31
v_add_f32_dpp v24, v24, v24 quad_perm:[1,0,3,2] row_mask:0xf bank_mask:0xf
v_add_f32_dpp v25, v25, v25 quad_perm:[1,0,3,2] row_mask:0xf bank_mask:0xf
v_add_f32_dpp v26, v26, v26 quad_perm:[1,0,3,2] row_mask:0xf bank_mask:0xf
v_add_f32_dpp v27, v27, v27 quad_perm:[1,0,3,2] row_mask:0xf bank_mask:0xf
v_add_f32_dpp v24, v24, v24 quad_perm:[2,3,0,1] row_mask:0xf bank_mask:0xf
v_add_f32_dpp v25, v25, v25 quad_perm:[2,3,0,1] row_mask:0xf bank_mask:0xf
v_add_f32_dpp v26, v26, v26 quad_perm:[2,3,0,1] row_mask:0xf bank_mask:0xf
v_add_f32_dpp v27, v27, v27 quad_perm:[2,3,0,1] row_mask:0xf bank_mask:0xf
v_add_f32_dpp v24, v24, v24 row_ror:4 row_mask:0xf bank_mask:0xf
v_add_f32_dpp v25, v25, v25 row_ror:4 row_mask:0xf bank_mask:0xf
v_add_f32_dpp v26, v26, v26 row_ror:4 row_mask:0xf bank_mask:0xf
v_add_f32_dpp v27, v27, v27 row_ror:4 row_mask:0xf bank_mask:0xf
v_add_f32_dpp v24, v24, v24 row_ror:8 row_mask:0xf bank_mask:0xf
v_add_f32_dpp v25, v25, v25 row_ror:8 row_mask:0xf bank_mask:0xf
v_add_f32_dpp v26, v26, v26 row_ror:8 row_mask:0xf bank_mask:0xf
v_add_f32_dpp v27, v27, v27 row_ror:8 row_mask:0xf bank_mask:0xf
v_cvt_pk_bf16_f32 v24, v24, v25
v_cvt_pk_bf16_f32 v25, v26, v27
s_cmp_lt_u32 s2, 14
v_mov_b32_dpp v64, v24 quad_perm:[0,1,2,3] row_mask:0xf bank_mask:1
v_mov_b32_dpp v65, v25 quad_perm:[0,1,2,3] row_mask:0xf bank_mask:1
v_mov_b32_dpp v66, v24 quad_perm:[0,1,2,3] row_mask:0xf bank_mask:2
v_mov_b32_dpp v67, v25 quad_perm:[0,1,2,3] row_mask:0xf bank_mask:2
v_mov_b32_dpp v68, v24 quad_perm:[0,1,2,3] row_mask:0xf bank_mask:4
v_mov_b32_dpp v69, v25 quad_perm:[0,1,2,3] row_mask:0xf bank_mask:4
v_mov_b32_dpp v70, v24 quad_perm:[0,1,2,3] row_mask:0xf bank_mask:8
v_mov_b32_dpp v71, v25 quad_perm:[0,1,2,3] row_mask:0xf bank_mask:8
v_mfma_f32_16x16x32_bf16 v[16:19], v[64:67], v[128:131], v[16:19]
v_mfma_f32_16x16x32_bf16 v[20:23], v[64:67], v[136:139], v[20:23]
v_mfma_f32_16x16x32_bf16 v[16:19], v[68:71], v[132:135], v[16:19]
v_mfma_f32_16x16x32_bf16 v[20:23], v[68:71], v[140:143], v[20:23]
s_nop 6
v_bfi_b32 v24, v59, v46, v16
v_bfi_b32 v25, v59, v47, v20
s_nop 0
v_mov_b32_dpp v26, v24 quad_perm:[1,1,3,3] row_mask:0xf bank_mask:0xf
v_mov_b32_dpp v27, v25 quad_perm:[1,1,3,3] row_mask:0xf bank_mask:0xf
s_mov_b64 exec, s[78:79]
s_cbranch_execz L_p3
global_store_dwordx4 v44, v[24:27], s[22:23] sc1
L_p3:
s_mov_b64 exec, s[76:77]
s_cbranch_execz L_p4
global_store_dwordx4 v45, v[24:27], s[22:23]
L_p4:
s_mov_b64 exec, -1
s_cbranch_scc0 L_fin
s_mov_b32 s10, 4194304
L_h2:
global_load_dwordx4 v[28:31], v48, s[22:23] sc1
s_sub_u32 s10, s10, 1
s_cbranch_scc1 L_h2k
s_waitcnt vmcnt(0)
v_xor_b32 v32, s70, v28
v_bitop3_b32 v32, v29, s72, v32 bitop3:0xbe
v_bitop3_b32 v32, v30, s74, v32 bitop3:0xbe
v_bitop3_b32 v32, v31, s80, v32 bitop3:0xbe
v_lshlrev_b32 v32, 20, v32
v_cmp_ne_u32 vcc, 0, v32
s_and_b64 exec, exec, vcc
s_cbranch_scc1 L_h2
L_h2k:
s_mov_b64 exec, -1
s_waitcnt vmcnt(0)
v_bfi_b32 v28, v59, v74, v28
v_bfi_b32 v30, v59, v74, v30
v_bfi_b32 v29, v59, v74, v29
v_bfi_b32 v31, v59, v74, v31
v_permlane32_swap_b32 v28, v30
s_nop 0
v_permlane32_swap_b32 v29, v31
v_add_f32 v28, v28, v30
v_add_f32 v29, v29, v31
s_nop 1
v_permlane16_swap_b32 v28, v29
v_add_f32 v24, v28, v29
s_nop 1
v_add_f32_dpp v24, v24, v24 quad_perm:[1,0,3,2] row_mask:0xf bank_mask:0xf
s_nop 1
v_add_f32_dpp v24, v24, v24 quad_perm:[2,3,0,1] row_mask:0xf bank_mask:0xf
s_nop 1
v_add_f32_dpp v24, v24, v24 row_ror:4 row_mask:0xf bank_mask:0xf
s_nop 1
v_add_f32_dpp v24, v24, v24 row_ror:8 row_mask:0xf bank_mask:0xf
s_mov_b32 exec_lo, 0x00010001
s_mov_b32 exec_hi, 0x00010001
ds_write_b32 v57, v24 offset:1152
s_mov_b64 exec, -1
s_waitcnt lgkmcnt(0)
s_barrier
s_cmp_eq_u32 s3, 0
s_cbranch_scc0 L_fin
ds_read_b128 v[28:31], v58 offset:1152
v_mov_b32 v11, 0
v_mov_b32 v17, s34
s_waitcnt lgkmcnt(0)
v_add_f32 v28, v28, v29
v_add_f32 v30, v30, v31
v_add_f32 v28, v28, v73
v_add_f32 v24, v28, v30
v_add_f32 v25, v28, v30
s_mov_b32 s56, 1
s_mov_b32 s57, 1
v_permlane16_swap_b32 v24, v25
v_cvt_pk_bf16_f32 v24, v24, v25
s_mov_b64 exec, s[56:57]
global_store_dword v72, v24, s[20:21]
s_cmp_eq_u32 s45, 0
s_cbranch_scc0 L_noep
s_mov_b64 exec, 1
global_store_dword v11, v17, s[22:23] sc1
L_noep:
s_mov_b64 exec, -1
L_fin:
L_end:
s_endpgm
.section .rodata,"a"
.p2align 6
.amdhsa_kernel parallel_sum__gqa_block_cached__dense_activation_relu__decode_kernel
  .amdhsa_next_free_vgpr 168
  .amdhsa_next_free_sgpr 102
  .amdhsa_accum_offset 168
  .amdhsa_group_segment_fixed_size 0
  .amdhsa_kernarg_size 88
  .amdhsa_user_sgpr_count 2
  .amdhsa_user_sgpr_kernarg_segment_ptr 1
  .amdhsa_system_sgpr_workgroup_id_x 1
.end_amdhsa_kernel
```
